```python
import torch

def _softmax(x, axis=-1):
    return torch.softmax(x, dim=axis)
def _gelu(x):
    return torch.nn.functional.gelu(x, approximate="tanh")
def _silu(x):
    return torch.nn.functional.silu(x)
def _sigmoid(x):
    return torch.sigmoid(x)
def _layernorm(x, axis=-1, eps=1e-5):
    m = x.mean(dim=axis, keepdim=True)
    v = x.var(dim=axis, keepdim=True, unbiased=False)
    return (x - m) / torch.sqrt(v + eps)
def _scatter_add(tgt, idx, src, axis=0):
    return tgt.clone().index_add_(axis, idx, src)
def _segment_sum(src, seg, n):
    out = torch.zeros((n,) + src.shape[1:], dtype=src.dtype)
    return out.index_add_(0, seg, src)
def _pad(x, pw):
    flat = tuple(v for pair in reversed(pw) for v in pair)
    return torch.nn.functional.pad(x, flat)

kernel_name = 'parallel_sum__ssm_conv_s5__dense_activation_squared_relu__prompt'

def setup_inputs():

    _w = (lambda a: (lambda t: t.to(torch.bfloat16) if t.is_floating_point() else t)(torch.as_tensor(a)))
    def _A_setup():
        B, S, D = 1, 2048, 512
        P = D
        Lambda_re = -0.5 * (lambda _x: torch.exp(torch.as_tensor(_x)))((lambda *s: torch.randn(*s, dtype=torch.bfloat16) * 0.8)(P))
        Lambda_im = (lambda *s: torch.randn(*s, dtype=torch.bfloat16) * 0.8)(P) * 1.0
        B_re = (lambda *s: torch.randn(*s, dtype=torch.bfloat16) * 1.6)(P, D) * (D ** -0.5)
        B_im = (lambda *s: torch.randn(*s, dtype=torch.bfloat16) * 1.6)(P, D) * (D ** -0.5)
        C_re = (lambda *s: torch.randn(*s, dtype=torch.bfloat16) * 1.6)(D, P) * (P ** -0.5)
        C_im = (lambda *s: torch.randn(*s, dtype=torch.bfloat16) * 1.6)(D, P) * (P ** -0.5)
        log_dt = (lambda *s: torch.randn(*s, dtype=torch.bfloat16) * 0.8)(P) * 0.3 - 2.0
        Dskip = (lambda *s: torch.randn(*s, dtype=torch.bfloat16) * 0.4)(D)
        return {
            "x": _w((lambda *s: torch.randn(*s, dtype=torch.bfloat16) * 0.05)(B, S, D)),
            "Lambda_re": _w(Lambda_re),
            "Lambda_im": _w(Lambda_im),
            "B_re": _w(B_re),
            "B_im": _w(B_im),
            "C_re": _w(C_re),
            "C_im": _w(C_im),
            "log_dt": _w(log_dt),
            "Dskip": _w(Dskip),
        }
    _A_in = _A_setup()

    def _B_setup():
        B, S, D, F = 1, 2048, 512, 1792
        return {
            "x": _w((lambda *s: torch.randn(*s, dtype=torch.bfloat16) * 0.05)(B, S, D)),
            "w1": _w((lambda *s: torch.randn(*s, dtype=torch.bfloat16) * 0.05)(D, F)),
            "b1": _w((lambda *s: torch.randn(*s, dtype=torch.bfloat16) * 0.2)(F)),
            "w2": _w((lambda *s: torch.randn(*s, dtype=torch.bfloat16) * 0.05)(F, D)),
            "b2": _w((lambda *s: torch.randn(*s, dtype=torch.bfloat16) * 1.6)(D)),
        }
    _B_in = _B_setup()

    return {
        "A_x": _A_in["x"],
        "A_Lambda_re": _A_in["Lambda_re"],
        "A_Lambda_im": _A_in["Lambda_im"],
        "A_B_re": _A_in["B_re"],
        "A_B_im": _A_in["B_im"],
        "A_C_re": _A_in["C_re"],
        "A_C_im": _A_in["C_im"],
        "A_log_dt": _A_in["log_dt"],
        "A_Dskip": _A_in["Dskip"],
        "B_x": _B_in["x"],
        "B_w1": _B_in["w1"],
        "B_b1": _B_in["b1"],
        "B_w2": _B_in["w2"],
        "B_b2": _B_in["b2"],
    }

def reference(A_x, A_Lambda_re, A_Lambda_im, A_B_re, A_B_im, A_C_re, A_C_im, A_log_dt, A_Dskip, B_x, B_w1, B_b1, B_w2, B_b2):
    def _A_ref(x, Lambda_re, Lambda_im, B_re, B_im, C_re, C_im, log_dt, Dskip):
        Bsz, L, H = x.shape
        Lam = Lambda_re + 1j * Lambda_im
        Bmat = B_re + 1j * B_im
        Cmat = C_re + 1j * C_im
        dt = torch.exp(log_dt)
        Lam_bar = torch.exp(dt * Lam)
        B_bar = ((Lam_bar - 1.0) / Lam)[:, None] * Bmat
        Bu = torch.einsum("bld,pd->blp", x + 0j, B_bar)
        h = torch.zeros_like(Bu[:, 0, :])
        hs = []
        for t in range(L):
            h = Lam_bar[None, :] * h + Bu[:, t, :]
            hs.append(h)
        hseq = torch.stack(hs, 1)
        y = 2.0 * torch.einsum("blp,dp->bld", hseq, Cmat).real + x * Dskip[None, None, :]
        return y

    def _B_ref(x, w1, b1, w2, b2):
        h = torch.einsum("bsd,df->bsf", x, w1) + b1
        zero = torch.zeros_like(h)
        r = torch.where(h > zero, h, zero)
        h = r * r
        out = torch.einsum("bsf,fd->bsd", h, w2) + b2
        return out

    x = A_x
    xn = _layernorm(x, axis=-1)
    return x + _A_ref(xn, A_Lambda_re, A_Lambda_im, A_B_re, A_B_im, A_C_re, A_C_im, A_log_dt, A_Dskip) + _B_ref(xn, B_w1, B_b1, B_w2, B_b2)
```

```asm
; @launch grid=(256,1,1) block=(256,1,1) lds=163840
.amdgcn_target "amdgcn-amd-amdhsa--gfx950"
.text
.globl parallel_sum__ssm_conv_s5__dense_activation_squared_relu__prompt_kernel
.p2align 8
.type parallel_sum__ssm_conv_s5__dense_activation_squared_relu__prompt_kernel,@function
parallel_sum__ssm_conv_s5__dense_activation_squared_relu__prompt_kernel:
  s_load_dwordx16 s[16:31], s[0:1], 0
  s_load_dwordx16 s[32:47], s[0:1], 64
  s_load_dwordx2 s[48:49], s[0:1], 128
  s_cmp_ge_u32 s2, 256
  s_cbranch_scc1 Lend
  v_lshrrev_b32 v1, 6, v0
  s_nop 0
  v_readfirstlane_b32 s3, v1
  v_and_b32 v1, 63, v0
  v_and_b32 v2, 15, v1
  v_lshrrev_b32 v3, 4, v1
  s_and_b32 s9, s2, 7
  s_lshr_b32 s10, s2, 3
  s_getpc_b64 s[92:93]
Lpc:
  s_and_b32 s11, s10, 7
  s_lshl_b32 s11, s11, 2
  s_add_u32 s11, s11, s3
  s_lshl_b32 s11, s11, 12
  v_lshrrev_b32 v67, 1, v1
  v_lshlrev_b32 v67, 7, v67
  v_add_u32 v67, s11, v67
  v_min_u32 v67, Lend-Lpc, v67
  v_mov_b32 v69, s93
  v_add_co_u32 v68, vcc, s92, v67
  v_addc_co_u32 v69, vcc, 0, v69, vcc
  global_load_dword a127, v[68:69], off
  s_lshr_b32 s11, s9, 1
  s_lshl_b32 s11, s11, 2
  s_and_b32 s51, s10, 3
  s_add_u32 s4, s11, s51
  s_and_b32 s11, s9, 1
  s_lshl_b32 s11, s11, 3
  s_lshr_b32 s12, s10, 2
  s_add_u32 s5, s11, s12
  s_lshl_b32 s8, s3, 15
  s_lshl_b32 s12, s4, 17
  s_add_u32 s12, s12, s8
  v_lshlrev_b32 v62, 4, v1
  s_mov_b32 m0, s8
  v_xor_b32 v128, 0, v62
  v_xor_b32 v129, 16, v62
  v_xor_b32 v130, 32, v62
  v_xor_b32 v131, 48, v62
  v_xor_b32 v132, 64, v62
  v_xor_b32 v133, 80, v62
  v_xor_b32 v134, 96, v62
  v_xor_b32 v135, 112, v62
  v_xor_b32 v136, 128, v62
  v_xor_b32 v137, 144, v62
  v_xor_b32 v138, 160, v62
  v_xor_b32 v139, 176, v62
  v_xor_b32 v140, 192, v62
  v_xor_b32 v141, 208, v62
  v_xor_b32 v142, 224, v62
  v_xor_b32 v143, 240, v62
  v_and_b32 v60, 31, v1
  s_lshl_b32 s11, s5, 5
  v_add_u32 v61, s11, v60
  v_lshlrev_b32 v61, 1, v61
  s_waitcnt lgkmcnt(0)
  s_mov_b32 s52, s16
  s_mov_b32 s53, s17
  s_mov_b32 s54, 2097152
  s_mov_b32 s55, 0x20000
  global_load_ushort v64, v61, s[18:19]
  global_load_ushort v65, v61, s[20:21]
  global_load_ushort v66, v61, s[30:31]
  s_lshr_b32 s15, s10, 2
  s_mul_i32 s15, s15, 4096
  s_add_u32 s15, s15, s12
  v_lshlrev_b32 v67, 6, v1
  buffer_load_dword a127, v67, s[52:55], s15 offen
  s_mov_b32 s60, s36
  s_mov_b32 s61, s37
  s_mov_b32 s62, 1835008
  s_mov_b32 s63, 0x20000
  s_mov_b32 s68, s26
  s_mov_b32 s69, s27
  s_mov_b32 s70, 524288
  s_mov_b32 s71, 0x20000
  s_mov_b32 s72, s28
  s_mov_b32 s73, s29
  s_mov_b32 s74, 524288
  s_mov_b32 s75, 0x20000
  s_mov_b32 s76, s40
  s_mov_b32 s77, s41
  s_mov_b32 s78, 1835008
  s_mov_b32 s79, 0x20000
  s_cmp_ge_u32 s3, 2
  s_cselect_b32 s56, s24, s22
  s_cselect_b32 s57, s25, s23
  s_mov_b32 s58, 524288
  s_mov_b32 s59, 0x20000
  v_lshlrev_b32 v84, 7, v1
  v_lshl_add_u32 v85, v3, 24, v84
  v_lshrrev_b32 v86, 3, v1
  v_lshl_add_u32 v86, v86, 24, v84
  s_lshl_b32 s15, s2, 2
  s_add_u32 s15, s15, s3
  s_lshl_b32 s15, s15, 11
  s_and_b32 s14, s3, 1
  s_lshl_b32 s50, s2, 1
  s_add_u32 s14, s14, s50
  s_lshl_b32 s14, s14, 10
  buffer_load_dword a127, v85, s[60:63], s15 offen
  buffer_load_dword a127, v86, s[56:59], s14 offen
  s_mov_b32 s94, s12
  buffer_load_dwordx4 v128, s[52:55], s94 offen lds
  buffer_load_dwordx4 v128, s[52:55], s94 offen offset:1024 lds
  s_add_u32 s94, s94, 2048
  s_add_u32 m0, m0, 2048
  s_movk_i32 s15, 4682
  s_movk_i32 s50, 3584
  v_add_u32 v67, 0, v1
  v_mul_u32_u24 v68, s15, v67
  v_lshrrev_b32 v68, 16, v68
  v_mul_u32_u24 v69, 14, v68
  v_sub_u32 v67, v67, v69
  v_and_b32 v69, 12, v68
  buffer_load_dwordx4 v129, s[52:55], s94 offen lds
  buffer_load_dwordx4 v129, s[52:55], s94 offen offset:1024 lds
  s_add_u32 s94, s94, 2048
  s_add_u32 m0, m0, 2048
  v_lshlrev_b32 v69, 1, v69
  v_and_b32 v70, 3, v68
  v_add_u32 v69, v69, v70
  v_lshrrev_b32 v68, 4, v68
  v_lshl_add_u32 v69, v68, 2, v69
  v_mul_u32_u24 v69, s50, v69
  v_lshl_add_u32 v20, v67, 4, v69
  v_add_u32 v67, 64, v1
  buffer_load_dwordx4 v130, s[52:55], s94 offen lds
  buffer_load_dwordx4 v130, s[52:55], s94 offen offset:1024 lds
  s_add_u32 s94, s94, 2048
  s_add_u32 m0, m0, 2048
  v_mul_u32_u24 v68, s15, v67
  v_lshrrev_b32 v68, 16, v68
  v_mul_u32_u24 v69, 14, v68
  v_sub_u32 v67, v67, v69
  v_and_b32 v69, 12, v68
  v_lshlrev_b32 v69, 1, v69
  v_and_b32 v70, 3, v68
  v_add_u32 v69, v69, v70
  buffer_load_dwordx4 v131, s[52:55], s94 offen lds
  buffer_load_dwordx4 v131, s[52:55], s94 offen offset:1024 lds
  s_add_u32 s94, s94, 2048
  s_add_u32 m0, m0, 2048
  v_lshrrev_b32 v68, 4, v68
  v_lshl_add_u32 v69, v68, 2, v69
  v_mul_u32_u24 v69, s50, v69
  v_lshl_add_u32 v21, v67, 4, v69
  v_subrev_u32 v21, 1024, v21
  v_add_u32 v67, 128, v1
  v_mul_u32_u24 v68, s15, v67
  v_lshrrev_b32 v68, 16, v68
  buffer_load_dwordx4 v132, s[52:55], s94 offen lds
  buffer_load_dwordx4 v132, s[52:55], s94 offen offset:1024 lds
  s_add_u32 s94, s94, 2048
  s_add_u32 m0, m0, 2048
  v_mul_u32_u24 v69, 14, v68
  v_sub_u32 v67, v67, v69
  v_and_b32 v69, 12, v68
  v_lshlrev_b32 v69, 1, v69
  v_and_b32 v70, 3, v68
  v_add_u32 v69, v69, v70
  v_lshrrev_b32 v68, 4, v68
  v_lshl_add_u32 v69, v68, 2, v69
  buffer_load_dwordx4 v133, s[52:55], s94 offen lds
  buffer_load_dwordx4 v133, s[52:55], s94 offen offset:1024 lds
  s_add_u32 s94, s94, 2048
  s_add_u32 m0, m0, 2048
  v_mul_u32_u24 v69, s50, v69
  v_lshl_add_u32 v22, v67, 4, v69
  v_subrev_u32 v22, 2048, v22
  v_add_u32 v67, 192, v1
  v_mul_u32_u24 v68, s15, v67
  v_lshrrev_b32 v68, 16, v68
  v_mul_u32_u24 v69, 14, v68
  v_sub_u32 v67, v67, v69
  buffer_load_dwordx4 v134, s[52:55], s94 offen lds
  buffer_load_dwordx4 v134, s[52:55], s94 offen offset:1024 lds
  s_add_u32 s94, s94, 2048
  s_add_u32 m0, m0, 2048
  v_and_b32 v69, 12, v68
  v_lshlrev_b32 v69, 1, v69
  v_and_b32 v70, 3, v68
  v_add_u32 v69, v69, v70
  v_lshrrev_b32 v68, 4, v68
  v_lshl_add_u32 v69, v68, 2, v69
  v_mul_u32_u24 v69, s50, v69
  v_lshl_add_u32 v23, v67, 4, v69
  buffer_load_dwordx4 v135, s[52:55], s94 offen lds
  buffer_load_dwordx4 v135, s[52:55], s94 offen offset:1024 lds
  s_add_u32 s94, s94, 2048
  s_add_u32 m0, m0, 2048
  v_subrev_u32 v23, 3072, v23
  v_add_u32 v67, 256, v1
  v_mul_u32_u24 v68, s15, v67
  v_lshrrev_b32 v68, 16, v68
  v_mul_u32_u24 v69, 14, v68
  v_sub_u32 v67, v67, v69
  v_and_b32 v69, 12, v68
  v_lshlrev_b32 v69, 1, v69
  buffer_load_dwordx4 v136, s[52:55], s94 offen lds
  buffer_load_dwordx4 v136, s[52:55], s94 offen offset:1024 lds
  s_add_u32 s94, s94, 2048
  s_add_u32 m0, m0, 2048
  v_and_b32 v70, 3, v68
  v_add_u32 v69, v69, v70
  v_lshrrev_b32 v68, 4, v68
  v_lshl_add_u32 v69, v68, 2, v69
  v_mul_u32_u24 v69, s50, v69
  v_lshl_add_u32 v24, v67, 4, v69
  v_add_u32 v67, 320, v1
  v_mul_u32_u24 v68, s15, v67
  buffer_load_dwordx4 v137, s[52:55], s94 offen lds
  buffer_load_dwordx4 v137, s[52:55], s94 offen offset:1024 lds
  s_add_u32 s94, s94, 2048
  s_add_u32 m0, m0, 2048
  v_lshrrev_b32 v68, 16, v68
  v_mul_u32_u24 v69, 14, v68
  v_sub_u32 v67, v67, v69
  v_and_b32 v69, 12, v68
  v_lshlrev_b32 v69, 1, v69
  v_and_b32 v70, 3, v68
  v_add_u32 v69, v69, v70
  v_lshrrev_b32 v68, 4, v68
  buffer_load_dwordx4 v138, s[52:55], s94 offen lds
  buffer_load_dwordx4 v138, s[52:55], s94 offen offset:1024 lds
  s_add_u32 s94, s94, 2048
  s_add_u32 m0, m0, 2048
  v_lshl_add_u32 v69, v68, 2, v69
  v_mul_u32_u24 v69, s50, v69
  v_lshl_add_u32 v25, v67, 4, v69
  v_subrev_u32 v25, 1024, v25
  v_add_u32 v67, 384, v1
  v_mul_u32_u24 v68, s15, v67
  v_lshrrev_b32 v68, 16, v68
  v_mul_u32_u24 v69, 14, v68
  buffer_load_dwordx4 v139, s[52:55], s94 offen lds
  buffer_load_dwordx4 v139, s[52:55], s94 offen offset:1024 lds
  s_add_u32 s94, s94, 2048
  s_add_u32 m0, m0, 2048
  v_sub_u32 v67, v67, v69
  v_and_b32 v69, 12, v68
  v_lshlrev_b32 v69, 1, v69
  v_and_b32 v70, 3, v68
  v_add_u32 v69, v69, v70
  v_lshrrev_b32 v68, 4, v68
  v_lshl_add_u32 v69, v68, 2, v69
  v_mul_u32_u24 v69, s50, v69
  v_lshl_add_u32 v26, v67, 4, v69
  v_subrev_u32 v26, 2048, v26
  s_mul_i32 s14, s5, 224
  s_mul_i32 s15, s3, 114688
  s_add_u32 s12, s14, s15
  s_mul_i32 s15, s3, 7168
  s_add_u32 m0, s15, 131072
  s_nop 0
  buffer_load_dwordx4 v20, s[60:63], s12 offen offset:0 lds
  buffer_load_dwordx4 v21, s[60:63], s12 offen offset:1024 lds
  buffer_load_dwordx4 v22, s[60:63], s12 offen offset:2048 lds
  buffer_load_dwordx4 v23, s[60:63], s12 offen offset:3072 lds
  s_add_u32 m0, m0, 4096
  s_nop 0
  buffer_load_dwordx4 v24, s[60:63], s12 offen offset:0 lds
  buffer_load_dwordx4 v25, s[60:63], s12 offen offset:1024 lds
  buffer_load_dwordx4 v26, s[60:63], s12 offen offset:2048 lds
  s_add_u32 s12, s12, 458752
  s_and_b32 s13, s3, 1
  s_lshl_b32 s13, s13, 2
  s_add_u32 s13, s13, s11
  s_lshl_b32 s13, s13, 10
  s_add_u32 m0, s8, 24576
  s_nop 0
  buffer_load_dwordx4 v140, s[52:55], s94 offen lds
  buffer_load_dwordx4 v140, s[52:55], s94 offen offset:1024 lds
  s_add_u32 s94, s94, 2048
  s_add_u32 m0, m0, 2048
  s_lshl_b32 s11, s9, 2
  s_and_b32 s15, s10, 3
  s_add_u32 s6, s11, s15
  s_lshr_b32 s7, s10, 2
  v_lshrrev_b32 v63, 5, v1
  v_add_u32 v4, 0, v63
  v_xor_b32 v4, v4, v60
  v_lshlrev_b32 v4, 4, v4
  v_add_u32 v5, 0, v63
  v_lshl_add_u32 v33, v5, 10, v4
  v_add_u32 v4, 2, v63
  v_xor_b32 v4, v4, v60
  v_lshlrev_b32 v4, 4, v4
  v_add_u32 v5, 1, v63
  v_lshl_add_u32 v34, v5, 10, v4
  v_add_u32 v4, 4, v63
  v_xor_b32 v4, v4, v60
  v_lshlrev_b32 v4, 4, v4
  v_add_u32 v5, 6, v63
  v_lshl_add_u32 v35, v5, 10, v4
  v_add_u32 v4, 6, v63
  v_xor_b32 v4, v4, v60
  v_lshlrev_b32 v4, 4, v4
  v_add_u32 v5, 7, v63
  v_lshl_add_u32 v36, v5, 10, v4
  v_add_u32 v4, 8, v63
  v_xor_b32 v4, v4, v60
  v_lshlrev_b32 v4, 4, v4
  v_add_u32 v5, 16, v63
  v_lshl_add_u32 v37, v5, 10, v4
  v_add_u32 v4, 10, v63
  v_xor_b32 v4, v4, v60
  v_lshlrev_b32 v4, 4, v4
  v_add_u32 v5, 17, v63
  v_lshl_add_u32 v38, v5, 10, v4
  v_add_u32 v4, 12, v63
  v_xor_b32 v4, v4, v60
  v_lshlrev_b32 v4, 4, v4
  v_add_u32 v5, 22, v63
  v_lshl_add_u32 v39, v5, 10, v4
  buffer_load_dwordx4 v141, s[52:55], s94 offen lds
  buffer_load_dwordx4 v141, s[52:55], s94 offen offset:1024 lds
  s_add_u32 s94, s94, 2048
  s_add_u32 m0, m0, 2048
  v_add_u32 v4, 14, v63
  v_xor_b32 v4, v4, v60
  v_lshlrev_b32 v4, 4, v4
  v_add_u32 v5, 23, v63
  v_lshl_add_u32 v40, v5, 10, v4
  s_mov_b32 s64, s48
  s_mov_b32 s65, s49
  s_mov_b32 s66, 33554432
  s_mov_b32 s67, 0x20000
  s_mov_b32 s80, s44
  s_mov_b32 s81, s45
  s_mov_b32 s82, 4194304
  s_mov_b32 s83, 0x20000
  s_mov_b32 s84, s46
  s_mov_b32 s85, s47
  s_mov_b32 s86, 256
  s_mov_b32 s87, 0x20000
  v_add_u32 v4, 0, v3
  v_xor_b32 v4, v4, v2
  v_lshlrev_b32 v4, 4, v4
  v_lshl_add_u32 v8, v2, 9, v4
  v_lshl_add_u32 v4, v2, 11, v4
  v_add_u32 v4, s8, v4
  v_add_u32 v12, 0x10000, v8
  v_add_u32 v16, 0x20000, v8
  v_add_u32 v5, 4, v3
  v_xor_b32 v5, v5, v2
  v_lshlrev_b32 v5, 4, v5
  v_lshl_add_u32 v9, v2, 9, v5
  v_lshl_add_u32 v5, v2, 11, v5
  v_add_u32 v5, s8, v5
  v_add_u32 v13, 0x10000, v9
  v_add_u32 v17, 0x20000, v9
  v_add_u32 v6, 8, v3
  v_xor_b32 v6, v6, v2
  v_lshlrev_b32 v6, 4, v6
  v_lshl_add_u32 v10, v2, 9, v6
  v_lshl_add_u32 v6, v2, 11, v6
  v_add_u32 v6, s8, v6
  v_add_u32 v14, 0x10000, v10
  buffer_load_dwordx4 v142, s[52:55], s94 offen lds
  buffer_load_dwordx4 v142, s[52:55], s94 offen offset:1024 lds
  s_add_u32 s94, s94, 2048
  s_add_u32 m0, m0, 2048
  v_add_u32 v18, 0x20000, v10
  v_add_u32 v7, 12, v3
  v_xor_b32 v7, v7, v2
  v_lshlrev_b32 v7, 4, v7
  v_lshl_add_u32 v11, v2, 9, v7
  v_lshl_add_u32 v7, v2, 11, v7
  v_add_u32 v7, s8, v7
  v_add_u32 v15, 0x10000, v11
  v_add_u32 v19, 0x20000, v11
  v_lshrrev_b32 v67, 2, v1
  v_mul_u32_u24 v67, 224, v67
  v_and_b32 v68, 3, v1
  v_lshl_add_u32 v27, v68, 3, v67
  v_add_u32 v28, 0x10000, v27
  v_add_u32 v29, 0x20000, v27
  v_mov_b32 v44, 0x3f803f80
  v_mov_b32 v45, 0x3f803f80
  v_mov_b32 v46, 0x3f803f80
  v_mov_b32 v47, 0x3f803f80
  s_lshl_b32 s15, s3, 5
  v_add_u32 v30, s15, v27
  v_add_u32 v31, s15, v28
  v_add_u32 v32, s15, v29
  v_lshlrev_b32 v43, 2, v60
  v_add_u32 v43, s8, v43
  s_lshl_b32 s15, s4, 2
  s_add_u32 s15, s15, s3
  s_lshl_b32 s15, s15, 4
  s_add_u32 s15, s15, s5
  s_mul_i32 s100, s15, 11520
  s_lshl_b32 s101, s15, 7
  s_add_u32 s101, s101, 17825792
  s_and_b32 s98, s3, 1
  s_lshr_b32 s99, s3, 1
  s_lshl_b32 s15, s6, 1
  s_add_u32 s96, s15, s99
  s_xor_b32 s97, s96, 1
  s_lshl_b32 s50, s3, 2
  s_lshl_b32 s96, s96, 4
  s_add_u32 s96, s96, s50
  buffer_load_dwordx4 v143, s[52:55], s94 offen lds
  buffer_load_dwordx4 v143, s[52:55], s94 offen offset:1024 lds
  s_add_u32 s94, s94, 2048
  s_add_u32 m0, m0, 2048
  s_mul_i32 s96, s96, 11520
  s_lshl_b32 s97, s97, 4
  s_add_u32 s97, s97, s50
  s_mul_i32 s97, s97, 11520
  s_lshl_b32 s15, s15, 4
  s_add_u32 s15, s15, s50
  s_lshl_b32 s15, s15, 7
  s_add_u32 s11, s15, 17825792
  s_mul_i32 s9, s3, 458752
  s_lshl_b32 s15, s7, 7
  s_add_u32 s9, s9, s15
  s_lshr_b32 s10, s2, 3
  s_lshl_b32 s51, s10, 2
  s_add_u32 s51, s51, s3
  s_lshl_b32 s51, s51, 12
  s_lshl_b32 s10, s10, 12
  s_mul_i32 s15, s3, 458752
  s_add_u32 s10, s10, s15
  v_lshlrev_b32 v41, 6, v1
  s_waitcnt vmcnt(42)
  v_lshlrev_b32 v64, 16, v64
  v_lshlrev_b32 v65, 16, v65
  v_lshlrev_b32 v66, 16, v66
  v_mul_f32 v66, 0x3fb8aa3b, v66
  v_exp_f32 v66, v66
  s_nop 0
  v_cvt_pk_bf16_f32 v66, v66, v66
  v_and_b32 v66, 0xffff0000, v66
  v_mul_f32 v80, v66, v64
  v_mul_f32 v81, v66, v65
  v_mul_f32 v80, 0x3fb8aa3b, v80
  v_mul_f32 v81, 0.15915494, v81
  v_mul_f32 v67, 1.0, v80
  v_mul_f32 v69, 1.0, v81
  v_exp_f32 v67, v67
  v_fract_f32 v69, v69
  v_cos_f32 v68, v69
  v_sin_f32 v69, v69
  v_mul_f32 v68, v67, v68
  v_mul_f32 v69, v67, v69
  v_mul_f32 v66, v64, v64
  v_fma_f32 v66, v65, v65, v66
  v_rcp_f32 v66, v66
  v_add_f32 v67, -1.0, v68
  v_add_f32 v66, v66, v66
  v_mul_f32 v70, v67, v64
  v_fma_f32 v70, v69, v65, v70
  v_mul_f32 v71, v69, v64
  v_fma_f32 v71, -v67, v65, v71
  v_mul_f32 v70, v70, v66
  v_mul_f32 v71, v71, v66
  v_mul_f32 v67, 2.0, v80
  v_mul_f32 v73, 2.0, v81
  v_exp_f32 v67, v67
  v_fract_f32 v73, v73
  v_cos_f32 v72, v73
  v_sin_f32 v73, v73
  v_mul_f32 v72, v67, v72
  v_mul_f32 v73, v67, v73
  v_mul_f32 v67, 4.0, v80
  v_mul_f32 v75, 4.0, v81
  v_exp_f32 v67, v67
  v_fract_f32 v75, v75
  v_cos_f32 v74, v75
  v_sin_f32 v75, v75
  v_mul_f32 v74, v67, v74
  v_mul_f32 v75, v67, v75
  v_mul_f32 v67, 0x41000000, v80
  v_mul_f32 v77, 0x41000000, v81
  v_exp_f32 v67, v67
  v_fract_f32 v77, v77
  v_cos_f32 v76, v77
  v_sin_f32 v77, v77
  v_mul_f32 v76, v67, v76
  v_mul_f32 v77, v67, v77
  v_mul_f32 v67, 0x41800000, v80
  v_mul_f32 v79, 0x41800000, v81
  v_exp_f32 v67, v67
  v_fract_f32 v79, v79
  v_cos_f32 v78, v79
  v_sin_f32 v79, v79
  v_mul_f32 v78, v67, v78
  v_mul_f32 v79, v67, v79
  s_or_b32 s15, s2, s3
  s_cmp_lg_u32 s15, 0
  s_cbranch_scc1 Lnotag
  s_memrealtime s[88:89]
  v_mov_b32 v90, 0
  s_waitcnt lgkmcnt(0)
  s_bitset1_b32 s89, 31
  v_mov_b32 v88, s88
  v_mov_b32 v89, s89
  buffer_store_dwordx2 v[88:89], v90, s[84:87], 0 offen sc1
Lnotag:
  s_waitcnt vmcnt(0)
  ds_read_b128 v[128:131], v4 offset:0
  ds_read_b128 v[132:135], v4 offset:1024
  ds_read_b128 v[136:139], v5 offset:0
  ds_read_b128 v[140:143], v5 offset:1024
  ds_read_b128 v[144:147], v6 offset:0
  ds_read_b128 v[148:151], v6 offset:1024
  ds_read_b128 v[152:155], v7 offset:0
  ds_read_b128 v[156:159], v7 offset:1024
  ds_read_b128 v[160:163], v4 offset:256
  ds_read_b128 v[164:167], v4 offset:1280
  ds_read_b128 v[168:171], v5 offset:256
  ds_read_b128 v[172:175], v5 offset:1280
  ds_read_b128 v[176:179], v6 offset:256
  ds_read_b128 v[180:183], v6 offset:1280
  ds_read_b128 v[184:187], v7 offset:256
  ds_read_b128 v[188:191], v7 offset:1280
  ds_read_b128 v[192:195], v4 offset:512
  ds_read_b128 v[196:199], v4 offset:1536
  ds_read_b128 v[200:203], v5 offset:512
  ds_read_b128 v[204:207], v5 offset:1536
  ds_read_b128 v[208:211], v6 offset:512
  ds_read_b128 v[212:215], v6 offset:1536
  ds_read_b128 v[216:219], v7 offset:512
  ds_read_b128 v[220:223], v7 offset:1536
  ds_read_b128 v[224:227], v4 offset:768
  ds_read_b128 v[228:231], v4 offset:1792
  ds_read_b128 v[232:235], v5 offset:768
  ds_read_b128 v[236:239], v5 offset:1792
  ds_read_b128 v[240:243], v6 offset:768
  ds_read_b128 v[244:247], v6 offset:1792
  ds_read_b128 v[248:251], v7 offset:768
  ds_read_b128 v[252:255], v7 offset:1792
  v_lshlrev_b32 v84, 7, v1
  v_lshrrev_b32 v85, 4, v1
  v_lshl_add_u32 v85, v85, 24, v84
  v_lshrrev_b32 v86, 2, v1
  v_lshl_add_u32 v86, v86, 24, v84
  s_lshl_b32 s15, s2, 2
  s_add_u32 s15, s15, s3
  s_lshl_b32 s14, s15, 11
  s_lshl_b32 s15, s15, 9
  buffer_load_dword a127, v86, s[68:71], s15 offen
  buffer_load_dword a127, v86, s[72:75], s15 offen
  buffer_load_dword a127, v85, s[76:79], s14 offen
  s_waitcnt lgkmcnt(0)
  s_barrier
  s_add_u32 m0, s8, 8192
  s_nop 0
  buffer_load_dwordx4 v20, s[60:63], s12 offen offset:0 lds
  ds_read_b64_tr_b16 a[8:9], v29 offset:0
  ds_read_b64_tr_b16 a[10:11], v29 offset:3584
  ds_read_b64_tr_b16 a[12:13], v29 offset:32
  ds_read_b64_tr_b16 a[14:15], v29 offset:3616
  ds_read_b64_tr_b16 a[16:17], v29 offset:64
  ds_read_b64_tr_b16 a[18:19], v29 offset:3648
  ds_read_b64_tr_b16 a[20:21], v29 offset:96
  ds_read_b64_tr_b16 a[22:23], v29 offset:3680
  ds_read_b64_tr_b16 a[24:25], v29 offset:128
  ds_read_b64_tr_b16 a[26:27], v29 offset:3712
  ds_read_b64_tr_b16 a[28:29], v29 offset:160
  ds_read_b64_tr_b16 a[30:31], v29 offset:3744
  ds_read_b64_tr_b16 a[32:33], v29 offset:192
  ds_read_b64_tr_b16 a[34:35], v29 offset:3776
  ds_read_b64_tr_b16 a[36:37], v32 offset:0
  ds_read_b64_tr_b16 a[38:39], v32 offset:3584
  ds_read_b64_tr_b16 a[40:41], v32 offset:128
  ds_read_b64_tr_b16 a[42:43], v32 offset:3712
  ds_write_b32 v43, v68 offset:29696
  ds_write_b32 v43, v69 offset:29824
  buffer_load_dwordx4 v21, s[60:63], s12 offen offset:1024 lds
  ds_write_b32 v43, v70 offset:29952
  ds_write_b32 v43, v71 offset:30080
  ds_write_b32 v43, v72 offset:30208
  ds_write_b32 v43, v73 offset:30336
  ds_write_b32 v43, v74 offset:30464
  ds_write_b32 v43, v75 offset:30592
  ds_write_b32 v43, v76 offset:30720
  ds_write_b32 v43, v77 offset:30848
  ds_write_b32 v43, v78 offset:30976
  ds_write_b32 v43, v79 offset:31104
  ds_write_b32 v43, v80 offset:31232
  ds_write_b32 v43, v81 offset:31360
  v_mfma_f32_16x16x32_bf16 v[120:123], v[44:47], v[128:131], 0
  v_mfma_f32_16x16x32_bf16 v[48:51], v[128:131], v[128:131], 0
  v_mfma_f32_16x16x32_bf16 v[124:127], v[44:47], v[132:135], 0
  buffer_load_dwordx4 v22, s[60:63], s12 offen offset:2048 lds
  v_mfma_f32_16x16x32_bf16 v[52:55], v[132:135], v[132:135], 0
  v_mfma_f32_16x16x32_bf16 v[120:123], v[44:47], v[136:139], v[120:123]
  v_mfma_f32_16x16x32_bf16 v[48:51], v[136:139], v[136:139], v[48:51]
  v_mfma_f32_16x16x32_bf16 v[124:127], v[44:47], v[140:143], v[124:127]
  v_mfma_f32_16x16x32_bf16 v[52:55], v[140:143], v[140:143], v[52:55]
  v_mfma_f32_16x16x32_bf16 v[120:123], v[44:47], v[144:147], v[120:123]
  v_mfma_f32_16x16x32_bf16 v[48:51], v[144:147], v[144:147], v[48:51]
  buffer_load_dwordx4 v23, s[60:63], s12 offen offset:3072 lds
  v_mfma_f32_16x16x32_bf16 v[124:127], v[44:47], v[148:151], v[124:127]
  v_mfma_f32_16x16x32_bf16 v[52:55], v[148:151], v[148:151], v[52:55]
  v_mfma_f32_16x16x32_bf16 v[120:123], v[44:47], v[152:155], v[120:123]
  v_mfma_f32_16x16x32_bf16 v[48:51], v[152:155], v[152:155], v[48:51]
  v_mfma_f32_16x16x32_bf16 v[124:127], v[44:47], v[156:159], v[124:127]
  v_mfma_f32_16x16x32_bf16 v[52:55], v[156:159], v[156:159], v[52:55]
  s_add_u32 m0, m0, 4096
  s_nop 0
  buffer_load_dwordx4 v24, s[60:63], s12 offen offset:0 lds
  v_mfma_f32_16x16x32_bf16 v[120:123], v[44:47], v[160:163], v[120:123]
  v_mfma_f32_16x16x32_bf16 v[48:51], v[160:163], v[160:163], v[48:51]
  v_mfma_f32_16x16x32_bf16 v[124:127], v[44:47], v[164:167], v[124:127]
  v_mfma_f32_16x16x32_bf16 v[52:55], v[164:167], v[164:167], v[52:55]
  v_mfma_f32_16x16x32_bf16 v[120:123], v[44:47], v[168:171], v[120:123]
  v_mfma_f32_16x16x32_bf16 v[48:51], v[168:171], v[168:171], v[48:51]
  v_mfma_f32_16x16x32_bf16 v[124:127], v[44:47], v[172:175], v[124:127]
  buffer_load_dwordx4 v25, s[60:63], s12 offen offset:1024 lds
  v_mfma_f32_16x16x32_bf16 v[52:55], v[172:175], v[172:175], v[52:55]
  v_mfma_f32_16x16x32_bf16 v[120:123], v[44:47], v[176:179], v[120:123]
  v_mfma_f32_16x16x32_bf16 v[48:51], v[176:179], v[176:179], v[48:51]
  v_mfma_f32_16x16x32_bf16 v[124:127], v[44:47], v[180:183], v[124:127]
  v_mfma_f32_16x16x32_bf16 v[52:55], v[180:183], v[180:183], v[52:55]
  v_mfma_f32_16x16x32_bf16 v[120:123], v[44:47], v[184:187], v[120:123]
  v_mfma_f32_16x16x32_bf16 v[48:51], v[184:187], v[184:187], v[48:51]
  buffer_load_dwordx4 v26, s[60:63], s12 offen offset:2048 lds
  s_add_u32 s12, s12, 458752
  v_mfma_f32_16x16x32_bf16 v[124:127], v[44:47], v[188:191], v[124:127]
  v_mfma_f32_16x16x32_bf16 v[52:55], v[188:191], v[188:191], v[52:55]
  v_mfma_f32_16x16x32_bf16 v[120:123], v[44:47], v[192:195], v[120:123]
  v_mfma_f32_16x16x32_bf16 v[48:51], v[192:195], v[192:195], v[48:51]
  v_mfma_f32_16x16x32_bf16 v[124:127], v[44:47], v[196:199], v[124:127]
  v_mfma_f32_16x16x32_bf16 v[52:55], v[196:199], v[196:199], v[52:55]
  s_add_u32 m0, s8, 15360
  s_nop 0
  buffer_load_dwordx4 v20, s[60:63], s12 offen offset:0 lds
  v_mfma_f32_16x16x32_bf16 v[120:123], v[44:47], v[200:203], v[120:123]
  v_mfma_f32_16x16x32_bf16 v[48:51], v[200:203], v[200:203], v[48:51]
  v_mfma_f32_16x16x32_bf16 v[124:127], v[44:47], v[204:207], v[124:127]
  v_mfma_f32_16x16x32_bf16 v[52:55], v[204:207], v[204:207], v[52:55]
  v_mfma_f32_16x16x32_bf16 v[120:123], v[44:47], v[208:211], v[120:123]
  v_mfma_f32_16x16x32_bf16 v[48:51], v[208:211], v[208:211], v[48:51]
  v_mfma_f32_16x16x32_bf16 v[124:127], v[44:47], v[212:215], v[124:127]
  buffer_load_dwordx4 v21, s[60:63], s12 offen offset:1024 lds
  v_mfma_f32_16x16x32_bf16 v[52:55], v[212:215], v[212:215], v[52:55]
  v_mfma_f32_16x16x32_bf16 v[120:123], v[44:47], v[216:219], v[120:123]
  v_mfma_f32_16x16x32_bf16 v[48:51], v[216:219], v[216:219], v[48:51]
  v_mfma_f32_16x16x32_bf16 v[124:127], v[44:47], v[220:223], v[124:127]
  v_mfma_f32_16x16x32_bf16 v[52:55], v[220:223], v[220:223], v[52:55]
  v_mfma_f32_16x16x32_bf16 v[120:123], v[44:47], v[224:227], v[120:123]
  v_mfma_f32_16x16x32_bf16 v[48:51], v[224:227], v[224:227], v[48:51]
  buffer_load_dwordx4 v22, s[60:63], s12 offen offset:2048 lds
  v_mfma_f32_16x16x32_bf16 v[124:127], v[44:47], v[228:231], v[124:127]
  v_mfma_f32_16x16x32_bf16 v[52:55], v[228:231], v[228:231], v[52:55]
  v_mfma_f32_16x16x32_bf16 v[120:123], v[44:47], v[232:235], v[120:123]
  v_mfma_f32_16x16x32_bf16 v[48:51], v[232:235], v[232:235], v[48:51]
  v_mfma_f32_16x16x32_bf16 v[124:127], v[44:47], v[236:239], v[124:127]
  v_mfma_f32_16x16x32_bf16 v[52:55], v[236:239], v[236:239], v[52:55]
  buffer_load_dwordx4 v23, s[60:63], s12 offen offset:3072 lds
  v_mfma_f32_16x16x32_bf16 v[120:123], v[44:47], v[240:243], v[120:123]
  v_mfma_f32_16x16x32_bf16 v[48:51], v[240:243], v[240:243], v[48:51]
  v_mfma_f32_16x16x32_bf16 v[124:127], v[44:47], v[244:247], v[124:127]
  v_mfma_f32_16x16x32_bf16 v[52:55], v[244:247], v[244:247], v[52:55]
  v_mfma_f32_16x16x32_bf16 v[120:123], v[44:47], v[248:251], v[120:123]
  v_mfma_f32_16x16x32_bf16 v[48:51], v[248:251], v[248:251], v[48:51]
  v_mfma_f32_16x16x32_bf16 v[124:127], v[44:47], v[252:255], v[124:127]
  s_add_u32 m0, m0, 4096
  s_nop 0
  buffer_load_dwordx4 v24, s[60:63], s12 offen offset:0 lds
  v_mfma_f32_16x16x32_bf16 v[52:55], v[252:255], v[252:255], v[52:55]
  s_waitcnt lgkmcnt(15)
  v_mfma_f32_16x16x32_bf16 v[64:67], a[8:11], v[128:131], 0
  ds_read_b64_tr_b16 a[44:45], v29 offset:7168
  ds_read_b64_tr_b16 a[46:47], v29 offset:10752
  v_mfma_f32_16x16x32_bf16 v[68:71], a[8:11], v[132:135], 0
  ds_read_b64_tr_b16 a[48:49], v29 offset:7200
  v_mfma_f32_16x16x32_bf16 v[72:75], a[12:15], v[128:131], 0
  ds_read_b64_tr_b16 a[50:51], v29 offset:10784
  v_mfma_f32_16x16x32_bf16 v[76:79], a[12:15], v[132:135], 0
  buffer_load_dwordx4 v25, s[60:63], s12 offen offset:1024 lds
  ds_read_b64_tr_b16 a[52:53], v29 offset:7232
  v_mfma_f32_16x16x32_bf16 v[80:83], a[16:19], v[128:131], 0
  ds_read_b64_tr_b16 a[54:55], v29 offset:10816
  v_mfma_f32_16x16x32_bf16 v[84:87], a[16:19], v[132:135], 0
  ds_read_b64_tr_b16 a[56:57], v29 offset:7264
  v_mfma_f32_16x16x32_bf16 v[88:91], a[20:23], v[128:131], 0
  ds_read_b64_tr_b16 a[58:59], v29 offset:10848
  v_mfma_f32_16x16x32_bf16 v[92:95], a[20:23], v[132:135], 0
  ds_read_b64_tr_b16 a[60:61], v29 offset:7296
  v_mfma_f32_16x16x32_bf16 v[96:99], a[24:27], v[128:131], 0
  buffer_load_dwordx4 v26, s[60:63], s12 offen offset:2048 lds
  s_add_u32 s12, s12, 458752
  ds_read_b64_tr_b16 a[62:63], v29 offset:10880
  ds_read_b64_tr_b16 a[64:65], v29 offset:7328
  v_mfma_f32_16x16x32_bf16 v[100:103], a[24:27], v[132:135], 0
  ds_read_b64_tr_b16 a[66:67], v29 offset:10912
  v_mfma_f32_16x16x32_bf16 v[104:107], a[28:31], v[128:131], 0
  ds_read_b64_tr_b16 a[68:69], v29 offset:7360
  v_mfma_f32_16x16x32_bf16 v[108:111], a[28:31], v[132:135], 0
  ds_read_b64_tr_b16 a[70:71], v29 offset:10944
  s_waitcnt lgkmcnt(15)
  v_mfma_f32_16x16x32_bf16 v[112:115], a[32:35], v[128:131], 0
  ds_read_b64_tr_b16 a[72:73], v32 offset:7168
  v_mfma_f32_16x16x32_bf16 v[116:119], a[32:35], v[132:135], 0
  s_add_u32 m0, s8, 22528
  s_nop 0
  buffer_load_dwordx4 v20, s[60:63], s12 offen offset:0 lds
  ds_read_b64_tr_b16 a[74:75], v32 offset:10752
  v_mfma_f32_16x16x32_bf16 a[0:3], a[36:39], v[44:47], 0
  ds_read_b64_tr_b16 a[76:77], v32 offset:7296
  v_mfma_f32_16x16x32_bf16 a[4:7], a[40:43], v[44:47], 0
  ds_read_b64_tr_b16 a[78:79], v32 offset:10880
  v_lshlrev_b32 v60, 2, v3
  v_sub_u32 v60, v2, v60
  v_mov_b32 v4, 0
  v_mov_b32 v6, 0
  v_cmp_eq_u32 vcc, 0, v60
  s_nop 1
  v_cndmask_b32 v4, v4, v48, vcc
  v_cndmask_b32 v6, v6, v52, vcc
  v_cmp_eq_u32 vcc, 1, v60
  s_nop 1
  v_cndmask_b32 v4, v4, v49, vcc
  buffer_load_dwordx4 v21, s[60:63], s12 offen offset:1024 lds
  v_cndmask_b32 v6, v6, v53, vcc
  v_cmp_eq_u32 vcc, 2, v60
  s_nop 1
  v_cndmask_b32 v4, v4, v50, vcc
  v_cndmask_b32 v6, v6, v54, vcc
  v_cmp_eq_u32 vcc, 3, v60
  s_nop 1
  v_cndmask_b32 v4, v4, v51, vcc
  v_cndmask_b32 v6, v6, v55, vcc
  v_mov_b32 v5, v4
  v_mov_b32 v7, v6
  s_nop 0
  v_permlane32_swap_b32 v4, v5
  v_permlane32_swap_b32 v6, v7
  v_add_f32 v4, v4, v5
  v_add_f32 v6, v6, v7
  v_mov_b32 v5, v4
  v_mov_b32 v7, v6
  s_nop 0
  v_permlane16_swap_b32 v4, v5
  v_permlane16_swap_b32 v6, v7
  v_add_f32 v4, v4, v5
  v_add_f32 v6, v6, v7
  v_mul_f32 v56, 0x3b000000, v120
  buffer_load_dwordx4 v22, s[60:63], s12 offen offset:2048 lds
  v_mul_f32 v4, 0x3b000000, v4
  v_fma_f32 v4, -v56, v56, v4
  v_max_f32 v4, 0, v4
  v_cvt_pk_bf16_f32 v56, v56, v56
  v_and_b32 v56, 0xffff0000, v56
  v_cvt_pk_bf16_f32 v4, v4, v4
  v_and_b32 v4, 0xffff0000, v4
  v_add_f32 v4, 0x3727c5ac, v4
  v_cvt_pk_bf16_f32 v4, v4, v4
  v_and_b32 v4, 0xffff0000, v4
  v_sqrt_f32 v4, v4
  s_nop 0
  v_cvt_pk_bf16_f32 v4, v4, v4
  v_and_b32 v4, 0xffff0000, v4
  v_rcp_f32 v57, v4
  v_mul_f32 v58, 0x3b000000, v124
  v_mul_f32 v6, 0x3b000000, v6
  v_fma_f32 v6, -v58, v58, v6
  v_max_f32 v6, 0, v6
  buffer_load_dwordx4 v23, s[60:63], s12 offen offset:3072 lds
  v_cvt_pk_bf16_f32 v58, v58, v58
  v_and_b32 v58, 0xffff0000, v58
  v_cvt_pk_bf16_f32 v6, v6, v6
  v_and_b32 v6, 0xffff0000, v6
  v_add_f32 v6, 0x3727c5ac, v6
  v_cvt_pk_bf16_f32 v6, v6, v6
  v_and_b32 v6, 0xffff0000, v6
  v_sqrt_f32 v6, v6
  s_nop 0
  v_cvt_pk_bf16_f32 v6, v6, v6
  v_and_b32 v6, 0xffff0000, v6
  v_rcp_f32 v59, v6
  s_waitcnt lgkmcnt(12)
  v_mfma_f32_16x16x32_bf16 v[64:67], a[44:47], v[136:139], v[64:67]
  ds_read_b64_tr_b16 a[8:9], v29 offset:14336
  ds_read_b64_tr_b16 a[10:11], v29 offset:17920
  v_mfma_f32_16x16x32_bf16 v[68:71], a[44:47], v[140:143], v[68:71]
  s_add_u32 m0, m0, 4096
  s_nop 0
  buffer_load_dwordx4 v24, s[60:63], s12 offen offset:0 lds
  ds_read_b64_tr_b16 a[12:13], v29 offset:14368
  v_mfma_f32_16x16x32_bf16 v[72:75], a[48:51], v[136:139], v[72:75]
  ds_read_b64_tr_b16 a[14:15], v29 offset:17952
  v_mfma_f32_16x16x32_bf16 v[76:79], a[48:51], v[140:143], v[76:79]
  ds_read_b64_tr_b16 a[16:17], v29 offset:14400
  v_mfma_f32_16x16x32_bf16 v[80:83], a[52:55], v[136:139], v[80:83]
  ds_read_b64_tr_b16 a[18:19], v29 offset:17984
  v_mfma_f32_16x16x32_bf16 v[84:87], a[52:55], v[140:143], v[84:87]
  ds_read_b64_tr_b16 a[20:21], v29 offset:14432
  s_waitcnt lgkmcnt(13)
  v_mfma_f32_16x16x32_bf16 v[88:91], a[56:59], v[136:139], v[88:91]
  buffer_load_dwordx4 v25, s[60:63], s12 offen offset:1024 lds
  ds_read_b64_tr_b16 a[22:23], v29 offset:18016
  v_mfma_f32_16x16x32_bf16 v[92:95], a[56:59], v[140:143], v[92:95]
  ds_read_b64_tr_b16 a[24:25], v29 offset:14464
  v_mfma_f32_16x16x32_bf16 v[96:99], a[60:63], v[136:139], v[96:99]
  ds_read_b64_tr_b16 a[26:27], v29 offset:18048
  ds_read_b64_tr_b16 a[28:29], v29 offset:14496
  v_mfma_f32_16x16x32_bf16 v[100:103], a[60:63], v[140:143], v[100:103]
  ds_read_b64_tr_b16 a[30:31], v29 offset:18080
  v_mfma_f32_16x16x32_bf16 v[104:107], a[64:67], v[136:139], v[104:107]
  ds_read_b64_tr_b16 a[32:33], v29 offset:14528
  buffer_load_dwordx4 v26, s[60:63], s12 offen offset:2048 lds
  s_add_u32 s12, s12, 458752
  v_mfma_f32_16x16x32_bf16 v[108:111], a[64:67], v[140:143], v[108:111]
  ds_read_b64_tr_b16 a[34:35], v29 offset:18112
  s_waitcnt lgkmcnt(14)
  v_mfma_f32_16x16x32_bf16 v[112:115], a[68:71], v[136:139], v[112:115]
  ds_read_b64_tr_b16 a[36:37], v32 offset:14336
  v_mfma_f32_16x16x32_bf16 v[116:119], a[68:71], v[140:143], v[116:119]
  ds_read_b64_tr_b16 a[38:39], v32 offset:17920
  v_mfma_f32_16x16x32_bf16 a[0:3], a[72:75], v[44:47], a[0:3]
  ds_read_b64_tr_b16 a[40:41], v32 offset:14464
  v_mfma_f32_16x16x32_bf16 a[4:7], a[76:79], v[44:47], a[4:7]
  ds_read_b64_tr_b16 a[42:43], v32 offset:18048
  s_waitcnt lgkmcnt(12)
  v_mfma_f32_16x16x32_bf16 v[64:67], a[8:11], v[144:147], v[64:67]
  ds_read_b64_tr_b16 a[44:45], v29 offset:21504
  ds_read_b64_tr_b16 a[46:47], v29 offset:25088
  v_mfma_f32_16x16x32_bf16 v[68:71], a[8:11], v[148:151], v[68:71]
  ds_read_b64_tr_b16 a[48:49], v29 offset:21536
  v_mfma_f32_16x16x32_bf16 v[72:75], a[12:15], v[144:147], v[72:75]
  ds_read_b64_tr_b16 a[50:51], v29 offset:25120
  v_mfma_f32_16x16x32_bf16 v[76:79], a[12:15], v[148:151], v[76:79]
  ds_read_b64_tr_b16 a[52:53], v29 offset:21568
  v_mfma_f32_16x16x32_bf16 v[80:83], a[16:19], v[144:147], v[80:83]
  ds_read_b64_tr_b16 a[54:55], v29 offset:25152
  v_mfma_f32_16x16x32_bf16 v[84:87], a[16:19], v[148:151], v[84:87]
  ds_read_b64_tr_b16 a[56:57], v29 offset:21600
  s_waitcnt lgkmcnt(13)
  v_mfma_f32_16x16x32_bf16 v[88:91], a[20:23], v[144:147], v[88:91]
  ds_read_b64_tr_b16 a[58:59], v29 offset:25184
  v_mfma_f32_16x16x32_bf16 v[92:95], a[20:23], v[148:151], v[92:95]
  ds_read_b64_tr_b16 a[60:61], v29 offset:21632
  v_mfma_f32_16x16x32_bf16 v[96:99], a[24:27], v[144:147], v[96:99]
  ds_read_b64_tr_b16 a[62:63], v29 offset:25216
  ds_read_b64_tr_b16 a[64:65], v29 offset:21664
  v_mfma_f32_16x16x32_bf16 v[100:103], a[24:27], v[148:151], v[100:103]
  ds_read_b64_tr_b16 a[66:67], v29 offset:25248
  v_mfma_f32_16x16x32_bf16 v[104:107], a[28:31], v[144:147], v[104:107]
  ds_read_b64_tr_b16 a[68:69], v29 offset:21696
  v_mfma_f32_16x16x32_bf16 v[108:111], a[28:31], v[148:151], v[108:111]
  ds_read_b64_tr_b16 a[70:71], v29 offset:25280
  s_waitcnt lgkmcnt(14)
  v_mfma_f32_16x16x32_bf16 v[112:115], a[32:35], v[144:147], v[112:115]
  ds_read_b64_tr_b16 a[72:73], v32 offset:21504
  v_mfma_f32_16x16x32_bf16 v[116:119], a[32:35], v[148:151], v[116:119]
  ds_read_b64_tr_b16 a[74:75], v32 offset:25088
  v_mfma_f32_16x16x32_bf16 a[0:3], a[36:39], v[44:47], a[0:3]
  ds_read_b64_tr_b16 a[76:77], v32 offset:21632
  v_mfma_f32_16x16x32_bf16 a[4:7], a[40:43], v[44:47], a[4:7]
  ds_read_b64_tr_b16 a[78:79], v32 offset:25216
  s_waitcnt lgkmcnt(0)
  s_waitcnt vmcnt(14)
  s_barrier
  s_lshl_b32 s51, s7, 16
  s_lshl_b32 s50, s3, 8
  s_add_u32 s51, s51, s50
  s_lshl_b32 s15, s3, 13
  s_add_u32 s15, s15, 131072
  v_add_u32 v120, 0, v3
  v_xor_b32 v120, v120, v2
  v_lshlrev_b32 v120, 4, v120
  v_lshl_add_u32 v124, v2, 8, v120
  v_add_u32 v48, s15, v124
  v_add_u32 v124, s8, v124
  v_lshl_add_u32 v120, v3, 10, v120
  v_add_u32 v121, 4, v3
  v_mfma_f32_16x16x32_bf16 v[64:67], a[44:47], v[152:155], v[64:67]
  ds_read_b64_tr_b16 a[8:9], v27 offset:8192
  ds_read_b64_tr_b16 a[10:11], v27 offset:11776
  v_mfma_f32_16x16x32_bf16 v[68:71], a[44:47], v[156:159], v[68:71]
  ds_read_b64_tr_b16 a[12:13], v27 offset:8224
  v_mfma_f32_16x16x32_bf16 v[72:75], a[48:51], v[152:155], v[72:75]
  v_xor_b32 v121, v121, v2
  v_lshlrev_b32 v121, 4, v121
  v_lshl_add_u32 v125, v2, 8, v121
  v_add_u32 v49, s15, v125
  v_add_u32 v125, s8, v125
  v_lshl_add_u32 v121, v3, 10, v121
  v_add_u32 v121, 3072, v121
  v_add_u32 v122, 8, v3
  ds_read_b64_tr_b16 a[14:15], v27 offset:11808
  v_mfma_f32_16x16x32_bf16 v[76:79], a[48:51], v[156:159], v[76:79]
  ds_read_b64_tr_b16 a[16:17], v27 offset:8256
  v_mfma_f32_16x16x32_bf16 v[80:83], a[52:55], v[152:155], v[80:83]
  ds_read_b64_tr_b16 a[18:19], v27 offset:11840
  v_mfma_f32_16x16x32_bf16 v[84:87], a[52:55], v[156:159], v[84:87]
  v_xor_b32 v122, v122, v2
  v_lshlrev_b32 v122, 4, v122
  v_lshl_add_u32 v126, v2, 8, v122
  v_add_u32 v50, s15, v126
  v_add_u32 v126, s8, v126
  v_lshl_add_u32 v122, v3, 10, v122
  v_add_u32 v122, 6144, v122
  v_add_u32 v123, 12, v3
  ds_read_b64_tr_b16 a[20:21], v27 offset:8288
  v_mfma_f32_16x16x32_bf16 v[88:91], a[56:59], v[152:155], v[88:91]
  ds_read_b64_tr_b16 a[22:23], v27 offset:11872
  v_mfma_f32_16x16x32_bf16 v[92:95], a[56:59], v[156:159], v[92:95]
  v_xor_b32 v123, v123, v2
  v_lshlrev_b32 v123, 4, v123
  v_lshl_add_u32 v127, v2, 8, v123
  v_add_u32 v51, s15, v127
  v_add_u32 v127, s8, v127
  v_lshl_add_u32 v123, v3, 10, v123
  v_add_u32 v123, 9216, v123
  ds_read_b64_tr_b16 a[24:25], v27 offset:8320
  v_mfma_f32_16x16x32_bf16 v[96:99], a[60:63], v[152:155], v[96:99]
  ds_read_b64_tr_b16 a[26:27], v27 offset:11904
  ds_read_b64_tr_b16 a[28:29], v27 offset:8352
  v_mfma_f32_16x16x32_bf16 v[100:103], a[60:63], v[156:159], v[100:103]
  ds_read_b64_tr_b16 a[30:31], v27 offset:11936
  v_mfma_f32_16x16x32_bf16 v[104:107], a[64:67], v[152:155], v[104:107]
  s_add_u32 m0, s8, 0
  s_nop 0
  buffer_load_dwordx4 v120, s[68:71], s51 offen offset:0 lds
  ds_read_b64_tr_b16 a[32:33], v27 offset:8384
  v_mfma_f32_16x16x32_bf16 v[108:111], a[64:67], v[156:159], v[108:111]
  ds_read_b64_tr_b16 a[34:35], v27 offset:11968
  v_mfma_f32_16x16x32_bf16 v[112:115], a[68:71], v[152:155], v[112:115]
  ds_read_b64_tr_b16 a[36:37], v30 offset:8192
  buffer_load_dwordx4 v121, s[68:71], s51 offen offset:1024 lds
  v_mfma_f32_16x16x32_bf16 v[116:119], a[68:71], v[156:159], v[116:119]
  ds_read_b64_tr_b16 a[38:39], v30 offset:11776
  v_mfma_f32_16x16x32_bf16 a[0:3], a[72:75], v[44:47], a[0:3]
  ds_read_b64_tr_b16 a[40:41], v30 offset:8320
  v_mfma_f32_16x16x32_bf16 a[4:7], a[76:79], v[44:47], a[4:7]
  buffer_load_dwordx4 v122, s[68:71], s51 offen offset:2048 lds
  ds_read_b64_tr_b16 a[42:43], v30 offset:11904
  s_waitcnt lgkmcnt(12)
  v_mfma_f32_16x16x32_bf16 v[64:67], a[8:11], v[160:163], v[64:67]
  ds_read_b64_tr_b16 a[44:45], v27 offset:40960
  ds_read_b64_tr_b16 a[46:47], v27 offset:44544
  v_mfma_f32_16x16x32_bf16 v[68:71], a[8:11], v[164:167], v[68:71]
  ds_read_b64_tr_b16 a[48:49], v27 offset:40992
  buffer_load_dwordx4 v123, s[68:71], s51 offen offset:3072 lds
  v_mfma_f32_16x16x32_bf16 v[72:75], a[12:15], v[160:163], v[72:75]
  ds_read_b64_tr_b16 a[50:51], v27 offset:44576
  v_mfma_f32_16x16x32_bf16 v[76:79], a[12:15], v[164:167], v[76:79]
  ds_read_b64_tr_b16 a[52:53], v27 offset:41024
  v_mfma_f32_16x16x32_bf16 v[80:83], a[16:19], v[160:163], v[80:83]
  s_add_u32 m0, s8, 4096
  s_nop 0
  buffer_load_dwordx4 v120, s[72:75], s51 offen offset:0 lds
  ds_read_b64_tr_b16 a[54:55], v27 offset:44608
  v_mfma_f32_16x16x32_bf16 v[84:87], a[16:19], v[164:167], v[84:87]
  ds_read_b64_tr_b16 a[56:57], v27 offset:41056
  s_waitcnt lgkmcnt(13)
  v_mfma_f32_16x16x32_bf16 v[88:91], a[20:23], v[160:163], v[88:91]
  ds_read_b64_tr_b16 a[58:59], v27 offset:44640
  v_mfma_f32_16x16x32_bf16 v[92:95], a[20:23], v[164:167], v[92:95]
  buffer_load_dwordx4 v121, s[72:75], s51 offen offset:1024 lds
  ds_read_b64_tr_b16 a[60:61], v27 offset:41088
  v_mfma_f32_16x16x32_bf16 v[96:99], a[24:27], v[160:163], v[96:99]
  ds_read_b64_tr_b16 a[62:63], v27 offset:44672
  ds_read_b64_tr_b16 a[64:65], v27 offset:41120
  v_mfma_f32_16x16x32_bf16 v[100:103], a[24:27], v[164:167], v[100:103]
  ds_read_b64_tr_b16 a[66:67], v27 offset:44704
  buffer_load_dwordx4 v122, s[72:75], s51 offen offset:2048 lds
  v_mfma_f32_16x16x32_bf16 v[104:107], a[28:31], v[160:163], v[104:107]
  ds_read_b64_tr_b16 a[68:69], v27 offset:41152
  v_mfma_f32_16x16x32_bf16 v[108:111], a[28:31], v[164:167], v[108:111]
  ds_read_b64_tr_b16 a[70:71], v27 offset:44736
  s_waitcnt lgkmcnt(14)
  v_mfma_f32_16x16x32_bf16 v[112:115], a[32:35], v[160:163], v[112:115]
  buffer_load_dwordx4 v123, s[72:75], s51 offen offset:3072 lds
  s_add_u32 s51, s51, 16384
  ds_read_b64_tr_b16 a[72:73], v30 offset:40960
  v_mfma_f32_16x16x32_bf16 v[116:119], a[32:35], v[164:167], v[116:119]
  ds_read_b64_tr_b16 a[74:75], v30 offset:44544
  v_mfma_f32_16x16x32_bf16 a[0:3], a[36:39], v[44:47], a[0:3]
  ds_read_b64_tr_b16 a[76:77], v30 offset:41088
  v_mfma_f32_16x16x32_bf16 a[4:7], a[40:43], v[44:47], a[4:7]
  s_add_u32 m0, s15, 0
  s_nop 0
  buffer_load_dwordx4 v120, s[68:71], s51 offen offset:0 lds
  ds_read_b64_tr_b16 a[78:79], v30 offset:44672
  s_waitcnt lgkmcnt(12)
  v_mfma_f32_16x16x32_bf16 v[64:67], a[44:47], v[168:171], v[64:67]
  ds_read_b64_tr_b16 a[8:9], v28 offset:8192
  ds_read_b64_tr_b16 a[10:11], v28 offset:11776
  v_mfma_f32_16x16x32_bf16 v[68:71], a[44:47], v[172:175], v[68:71]
  buffer_load_dwordx4 v121, s[68:71], s51 offen offset:1024 lds
  ds_read_b64_tr_b16 a[12:13], v28 offset:8224
  v_mfma_f32_16x16x32_bf16 v[72:75], a[48:51], v[168:171], v[72:75]
  ds_read_b64_tr_b16 a[14:15], v28 offset:11808
  v_mfma_f32_16x16x32_bf16 v[76:79], a[48:51], v[172:175], v[76:79]
  ds_read_b64_tr_b16 a[16:17], v28 offset:8256
  v_mfma_f32_16x16x32_bf16 v[80:83], a[52:55], v[168:171], v[80:83]
  buffer_load_dwordx4 v122, s[68:71], s51 offen offset:2048 lds
  ds_read_b64_tr_b16 a[18:19], v28 offset:11840
  v_mfma_f32_16x16x32_bf16 v[84:87], a[52:55], v[172:175], v[84:87]
  ds_read_b64_tr_b16 a[20:21], v28 offset:8288
  s_waitcnt lgkmcnt(13)
  v_mfma_f32_16x16x32_bf16 v[88:91], a[56:59], v[168:171], v[88:91]
  ds_read_b64_tr_b16 a[22:23], v28 offset:11872
  buffer_load_dwordx4 v123, s[68:71], s51 offen offset:3072 lds
  v_mfma_f32_16x16x32_bf16 v[92:95], a[56:59], v[172:175], v[92:95]
  ds_read_b64_tr_b16 a[24:25], v28 offset:8320
  v_mfma_f32_16x16x32_bf16 v[96:99], a[60:63], v[168:171], v[96:99]
  ds_read_b64_tr_b16 a[26:27], v28 offset:11904
  ds_read_b64_tr_b16 a[28:29], v28 offset:8352
  v_mfma_f32_16x16x32_bf16 v[100:103], a[60:63], v[172:175], v[100:103]
  s_add_u32 m0, s15, 4096
  s_nop 0
  buffer_load_dwordx4 v120, s[72:75], s51 offen offset:0 lds
  ds_read_b64_tr_b16 a[30:31], v28 offset:11936
  v_mfma_f32_16x16x32_bf16 v[104:107], a[64:67], v[168:171], v[104:107]
  ds_read_b64_tr_b16 a[32:33], v28 offset:8384
  v_mfma_f32_16x16x32_bf16 v[108:111], a[64:67], v[172:175], v[108:111]
  ds_read_b64_tr_b16 a[34:35], v28 offset:11968
  s_waitcnt lgkmcnt(14)
  v_mfma_f32_16x16x32_bf16 v[112:115], a[68:71], v[168:171], v[112:115]
  buffer_load_dwordx4 v121, s[72:75], s51 offen offset:1024 lds
  ds_read_b64_tr_b16 a[36:37], v31 offset:8192
  v_mfma_f32_16x16x32_bf16 v[116:119], a[68:71], v[172:175], v[116:119]
  ds_read_b64_tr_b16 a[38:39], v31 offset:11776
  v_mfma_f32_16x16x32_bf16 a[0:3], a[72:75], v[44:47], a[0:3]
  ds_read_b64_tr_b16 a[40:41], v31 offset:8320
  buffer_load_dwordx4 v122, s[72:75], s51 offen offset:2048 lds
  v_mfma_f32_16x16x32_bf16 a[4:7], a[76:79], v[44:47], a[4:7]
  ds_read_b64_tr_b16 a[42:43], v31 offset:11904
  s_waitcnt lgkmcnt(12)
  v_mfma_f32_16x16x32_bf16 v[64:67], a[8:11], v[176:179], v[64:67]
  ds_read_b64_tr_b16 a[44:45], v28 offset:40960
  ds_read_b64_tr_b16 a[46:47], v28 offset:44544
  v_mfma_f32_16x16x32_bf16 v[68:71], a[8:11], v[180:183], v[68:71]
  buffer_load_dwordx4 v123, s[72:75], s51 offen offset:3072 lds
  s_add_u32 s51, s51, 16384
  ds_read_b64_tr_b16 a[48:49], v28 offset:40992
  v_mfma_f32_16x16x32_bf16 v[72:75], a[12:15], v[176:179], v[72:75]
  ds_read_b64_tr_b16 a[50:51], v28 offset:44576
  v_mfma_f32_16x16x32_bf16 v[76:79], a[12:15], v[180:183], v[76:79]
  ds_read_b64_tr_b16 a[52:53], v28 offset:41024
  v_mfma_f32_16x16x32_bf16 v[80:83], a[16:19], v[176:179], v[80:83]
  ds_read_b64_tr_b16 a[54:55], v28 offset:44608
  v_mfma_f32_16x16x32_bf16 v[84:87], a[16:19], v[180:183], v[84:87]
  ds_read_b64_tr_b16 a[56:57], v28 offset:41056
  s_waitcnt lgkmcnt(13)
  v_mfma_f32_16x16x32_bf16 v[88:91], a[20:23], v[176:179], v[88:91]
  s_waitcnt vmcnt(12)
  ds_read_b128 a[128:131], v124 offset:0
  ds_read_b128 a[160:163], v125 offset:0
  ds_read_b128 a[192:195], v126 offset:0
  ds_read_b128 a[224:227], v127 offset:0
  ds_read_b64_tr_b16 a[58:59], v28 offset:44640
  v_mfma_f32_16x16x32_bf16 v[92:95], a[20:23], v[180:183], v[92:95]
  ds_read_b64_tr_b16 a[60:61], v28 offset:41088
  v_mfma_f32_16x16x32_bf16 v[96:99], a[24:27], v[176:179], v[96:99]
  ds_read_b64_tr_b16 a[62:63], v28 offset:44672
  ds_read_b64_tr_b16 a[64:65], v28 offset:41120
  v_mfma_f32_16x16x32_bf16 v[100:103], a[24:27], v[180:183], v[100:103]
  s_waitcnt vmcnt(8)
  ds_read_b128 a[144:147], v124 offset:4096
  ds_read_b128 a[176:179], v125 offset:4096
  ds_read_b128 a[208:211], v126 offset:4096
  ds_read_b128 a[240:243], v127 offset:4096
  ds_read_b64_tr_b16 a[66:67], v28 offset:44704
  v_mfma_f32_16x16x32_bf16 v[104:107], a[28:31], v[176:179], v[104:107]
  ds_read_b64_tr_b16 a[68:69], v28 offset:41152
  v_mfma_f32_16x16x32_bf16 v[108:111], a[28:31], v[180:183], v[108:111]
  ds_read_b64_tr_b16 a[70:71], v28 offset:44736
  s_waitcnt lgkmcnt(11)
  s_add_u32 m0, s8, 0
  s_nop 0
  buffer_load_dwordx4 v120, s[68:71], s51 offen offset:0 lds
  v_mfma_f32_16x16x32_bf16 v[112:115], a[32:35], v[176:179], v[112:115]
  ds_read_b64_tr_b16 a[72:73], v31 offset:40960
  v_mfma_f32_16x16x32_bf16 v[116:119], a[32:35], v[180:183], v[116:119]
  ds_read_b64_tr_b16 a[74:75], v31 offset:44544
  v_mfma_f32_16x16x32_bf16 a[0:3], a[36:39], v[44:47], a[0:3]
  buffer_load_dwordx4 v121, s[68:71], s51 offen offset:1024 lds
  ds_read_b64_tr_b16 a[76:77], v31 offset:41088
  v_mfma_f32_16x16x32_bf16 a[4:7], a[40:43], v[44:47], a[4:7]
  ds_read_b64_tr_b16 a[78:79], v31 offset:44672
  s_barrier
  v_mfma_f32_16x16x32_bf16 v[64:67], a[44:47], v[184:187], v[64:67]
  buffer_load_dwordx4 v122, s[68:71], s51 offen offset:2048 lds
  ds_read_b64_tr_b16 a[8:9], v27 offset:15360
  ds_read_b64_tr_b16 a[10:11], v27 offset:18944
  v_mfma_f32_16x16x32_bf16 v[68:71], a[44:47], v[188:191], v[68:71]
  ds_read_b64_tr_b16 a[12:13], v27 offset:15392
  v_mfma_f32_16x16x32_bf16 v[72:75], a[48:51], v[184:187], v[72:75]
  ds_read_b64_tr_b16 a[14:15], v27 offset:18976
  v_mfma_f32_16x16x32_bf16 v[76:79], a[48:51], v[188:191], v[76:79]
  buffer_load_dwordx4 v123, s[68:71], s51 offen offset:3072 lds
  ds_read_b64_tr_b16 a[16:17], v27 offset:15424
  v_mfma_f32_16x16x32_bf16 v[80:83], a[52:55], v[184:187], v[80:83]
  ds_read_b64_tr_b16 a[18:19], v27 offset:19008
  v_mfma_f32_16x16x32_bf16 v[84:87], a[52:55], v[188:191], v[84:87]
  ds_read_b64_tr_b16 a[20:21], v27 offset:15456
  s_waitcnt vmcnt(8)
  ds_read_b128 a[132:135], v48 offset:0
  ds_read_b128 a[164:167], v49 offset:0
  ds_read_b128 a[196:199], v50 offset:0
  ds_read_b128 a[228:231], v51 offset:0
  s_waitcnt lgkmcnt(15)
  v_mfma_f32_16x16x32_bf16 v[88:91], a[56:59], v[184:187], v[88:91]
  ds_read_b64_tr_b16 a[22:23], v27 offset:19040
  v_mfma_f32_16x16x32_bf16 v[92:95], a[56:59], v[188:191], v[92:95]
  ds_read_b64_tr_b16 a[24:25], v27 offset:15488
  v_mfma_f32_16x16x32_bf16 v[96:99], a[60:63], v[184:187], v[96:99]
  s_add_u32 m0, s8, 4096
  s_nop 0
  buffer_load_dwordx4 v120, s[72:75], s51 offen offset:0 lds
  ds_read_b64_tr_b16 a[26:27], v27 offset:19072
  ds_read_b64_tr_b16 a[28:29], v27 offset:15520
  v_mfma_f32_16x16x32_bf16 v[100:103], a[60:63], v[188:191], v[100:103]
  ds_read_b64_tr_b16 a[30:31], v27 offset:19104
  v_mfma_f32_16x16x32_bf16 v[104:107], a[64:67], v[184:187], v[104:107]
  ds_read_b64_tr_b16 a[32:33], v27 offset:15552
  v_mfma_f32_16x16x32_bf16 v[108:111], a[64:67], v[188:191], v[108:111]
  buffer_load_dwordx4 v121, s[72:75], s51 offen offset:1024 lds
  ds_read_b64_tr_b16 a[34:35], v27 offset:19136
  s_waitcnt lgkmcnt(15)
  v_mfma_f32_16x16x32_bf16 v[112:115], a[68:71], v[184:187], v[112:115]
  ds_read_b64_tr_b16 a[36:37], v30 offset:15360
  v_mfma_f32_16x16x32_bf16 v[116:119], a[68:71], v[188:191], v[116:119]
  buffer_load_dwordx4 v122, s[72:75], s51 offen offset:2048 lds
  ds_read_b64_tr_b16 a[38:39], v30 offset:18944
  v_mfma_f32_16x16x32_bf16 a[0:3], a[72:75], v[44:47], a[0:3]
  ds_read_b64_tr_b16 a[40:41], v30 offset:15488
  v_mfma_f32_16x16x32_bf16 a[4:7], a[76:79], v[44:47], a[4:7]
  ds_read_b64_tr_b16 a[42:43], v30 offset:19072
  s_waitcnt lgkmcnt(15)
  v_mfma_f32_16x16x32_bf16 v[64:67], a[8:11], v[192:195], v[64:67]
  buffer_load_dwordx4 v123, s[72:75], s51 offen offset:3072 lds
  s_add_u32 s51, s51, 16384
  ds_read_b64_tr_b16 a[44:45], v27 offset:48128
  ds_read_b64_tr_b16 a[46:47], v27 offset:51712
  v_mfma_f32_16x16x32_bf16 v[68:71], a[8:11], v[196:199], v[68:71]
  ds_read_b64_tr_b16 a[48:49], v27 offset:48160
  v_mfma_f32_16x16x32_bf16 v[72:75], a[12:15], v[192:195], v[72:75]
  ds_read_b64_tr_b16 a[50:51], v27 offset:51744
  s_waitcnt vmcnt(8)
  ds_read_b128 a[148:151], v48 offset:4096
  ds_read_b128 a[180:183], v49 offset:4096
  ds_read_b128 a[212:215], v50 offset:4096
  ds_read_b128 a[244:247], v51 offset:4096
  v_mfma_f32_16x16x32_bf16 v[76:79], a[12:15], v[196:199], v[76:79]
  ds_read_b64_tr_b16 a[52:53], v27 offset:48192
  v_mfma_f32_16x16x32_bf16 v[80:83], a[16:19], v[192:195], v[80:83]
  ds_read_b64_tr_b16 a[54:55], v27 offset:51776
  v_mfma_f32_16x16x32_bf16 v[84:87], a[16:19], v[196:199], v[84:87]
  s_waitcnt lgkmcnt(15)
  s_add_u32 m0, s15, 0
  s_nop 0
  buffer_load_dwordx4 v120, s[68:71], s51 offen offset:0 lds
  ds_read_b64_tr_b16 a[56:57], v27 offset:48224
  v_mfma_f32_16x16x32_bf16 v[88:91], a[20:23], v[192:195], v[88:91]
  ds_read_b64_tr_b16 a[58:59], v27 offset:51808
  v_mfma_f32_16x16x32_bf16 v[92:95], a[20:23], v[196:199], v[92:95]
  ds_read_b64_tr_b16 a[60:61], v27 offset:48256
  v_mfma_f32_16x16x32_bf16 v[96:99], a[24:27], v[192:195], v[96:99]
  buffer_load_dwordx4 v121, s[68:71], s51 offen offset:1024 lds
  ds_read_b64_tr_b16 a[62:63], v27 offset:51840
  ds_read_b64_tr_b16 a[64:65], v27 offset:48288
  v_mfma_f32_16x16x32_bf16 v[100:103], a[24:27], v[196:199], v[100:103]
  ds_read_b64_tr_b16 a[66:67], v27 offset:51872
  v_mfma_f32_16x16x32_bf16 v[104:107], a[28:31], v[192:195], v[104:107]
  buffer_load_dwordx4 v122, s[68:71], s51 offen offset:2048 lds
  ds_read_b64_tr_b16 a[68:69], v27 offset:48320
  v_mfma_f32_16x16x32_bf16 v[108:111], a[28:31], v[196:199], v[108:111]
  ds_read_b64_tr_b16 a[70:71], v27 offset:51904
  s_waitcnt lgkmcnt(15)
  v_mfma_f32_16x16x32_bf16 v[112:115], a[32:35], v[192:195], v[112:115]
  ds_read_b64_tr_b16 a[72:73], v30 offset:48128
  v_mfma_f32_16x16x32_bf16 v[116:119], a[32:35], v[196:199], v[116:119]
  buffer_load_dwordx4 v123, s[68:71], s51 offen offset:3072 lds
  ds_read_b64_tr_b16 a[74:75], v30 offset:51712
  v_mfma_f32_16x16x32_bf16 a[0:3], a[36:39], v[44:47], a[0:3]
  ds_read_b64_tr_b16 a[76:77], v30 offset:48256
  v_mfma_f32_16x16x32_bf16 a[4:7], a[40:43], v[44:47], a[4:7]
  ds_read_b64_tr_b16 a[78:79], v30 offset:51840
  s_waitcnt lgkmcnt(12)
  s_add_u32 m0, s15, 4096
  s_nop 0
  buffer_load_dwordx4 v120, s[72:75], s51 offen offset:0 lds
  v_mfma_f32_16x16x32_bf16 v[64:67], a[44:47], v[200:203], v[64:67]
  ds_read_b64_tr_b16 a[8:9], v28 offset:15360
  ds_read_b64_tr_b16 a[10:11], v28 offset:18944
  v_mfma_f32_16x16x32_bf16 v[68:71], a[44:47], v[204:207], v[68:71]
  ds_read_b64_tr_b16 a[12:13], v28 offset:15392
  v_mfma_f32_16x16x32_bf16 v[72:75], a[48:51], v[200:203], v[72:75]
  buffer_load_dwordx4 v121, s[72:75], s51 offen offset:1024 lds
  ds_read_b64_tr_b16 a[14:15], v28 offset:18976
  v_mfma_f32_16x16x32_bf16 v[76:79], a[48:51], v[204:207], v[76:79]
  ds_read_b64_tr_b16 a[16:17], v28 offset:15424
  v_mfma_f32_16x16x32_bf16 v[80:83], a[52:55], v[200:203], v[80:83]
  ds_read_b64_tr_b16 a[18:19], v28 offset:19008
  v_mfma_f32_16x16x32_bf16 v[84:87], a[52:55], v[204:207], v[84:87]
  buffer_load_dwordx4 v122, s[72:75], s51 offen offset:2048 lds
  ds_read_b64_tr_b16 a[20:21], v28 offset:15456
  s_waitcnt lgkmcnt(13)
  v_mfma_f32_16x16x32_bf16 v[88:91], a[56:59], v[200:203], v[88:91]
  ds_read_b64_tr_b16 a[22:23], v28 offset:19040
  v_mfma_f32_16x16x32_bf16 v[92:95], a[56:59], v[204:207], v[92:95]
  ds_read_b64_tr_b16 a[24:25], v28 offset:15488
  buffer_load_dwordx4 v123, s[72:75], s51 offen offset:3072 lds
  s_add_u32 s51, s51, 16384
  v_mfma_f32_16x16x32_bf16 v[96:99], a[60:63], v[200:203], v[96:99]
  ds_read_b64_tr_b16 a[26:27], v28 offset:19072
  ds_read_b64_tr_b16 a[28:29], v28 offset:15520
  v_mfma_f32_16x16x32_bf16 v[100:103], a[60:63], v[204:207], v[100:103]
  ds_read_b64_tr_b16 a[30:31], v28 offset:19104
  v_mfma_f32_16x16x32_bf16 v[104:107], a[64:67], v[200:203], v[104:107]
  ds_read_b64_tr_b16 a[32:33], v28 offset:15552
  v_mfma_f32_16x16x32_bf16 v[108:111], a[64:67], v[204:207], v[108:111]
  ds_read_b64_tr_b16 a[34:35], v28 offset:19136
  s_waitcnt lgkmcnt(14)
  v_mfma_f32_16x16x32_bf16 v[112:115], a[68:71], v[200:203], v[112:115]
  ds_read_b64_tr_b16 a[36:37], v31 offset:15360
  s_waitcnt vmcnt(12)
  ds_read_b128 a[136:139], v124 offset:0
  ds_read_b128 a[168:171], v125 offset:0
  ds_read_b128 a[200:203], v126 offset:0
  ds_read_b128 a[232:235], v127 offset:0
  v_mfma_f32_16x16x32_bf16 v[116:119], a[68:71], v[204:207], v[116:119]
  ds_read_b64_tr_b16 a[38:39], v31 offset:18944
  v_mfma_f32_16x16x32_bf16 a[0:3], a[72:75], v[44:47], a[0:3]
  ds_read_b64_tr_b16 a[40:41], v31 offset:15488
  v_mfma_f32_16x16x32_bf16 a[4:7], a[76:79], v[44:47], a[4:7]
  s_waitcnt vmcnt(8)
  ds_read_b128 a[152:155], v124 offset:4096
  ds_read_b128 a[184:187], v125 offset:4096
  ds_read_b128 a[216:219], v126 offset:4096
  ds_read_b128 a[248:251], v127 offset:4096
  ds_read_b64_tr_b16 a[42:43], v31 offset:19072
  s_waitcnt lgkmcnt(15)
  v_mfma_f32_16x16x32_bf16 v[64:67], a[8:11], v[208:211], v[64:67]
  ds_read_b64_tr_b16 a[44:45], v28 offset:48128
  ds_read_b64_tr_b16 a[46:47], v28 offset:51712
  v_mfma_f32_16x16x32_bf16 v[68:71], a[8:11], v[212:215], v[68:71]
  ds_read_b64_tr_b16 a[48:49], v28 offset:48160
  v_mfma_f32_16x16x32_bf16 v[72:75], a[12:15], v[208:211], v[72:75]
  s_waitcnt lgkmcnt(4)
  s_mov_b32 m0, s8
  s_nop 0
  buffer_load_dwordx4 v33, s[56:59], s13 offen offset:0 lds
  ds_read_b64_tr_b16 a[50:51], v28 offset:51744
  v_mfma_f32_16x16x32_bf16 v[76:79], a[12:15], v[212:215], v[76:79]
  ds_read_b64_tr_b16 a[52:53], v28 offset:48192
  v_mfma_f32_16x16x32_bf16 v[80:83], a[16:19], v[208:211], v[80:83]
  ds_read_b64_tr_b16 a[54:55], v28 offset:51776
  buffer_load_dwordx4 v34, s[56:59], s13 offen offset:1024 lds
  v_mfma_f32_16x16x32_bf16 v[84:87], a[16:19], v[212:215], v[84:87]
  ds_read_b64_tr_b16 a[56:57], v28 offset:48224
  v_mfma_f32_16x16x32_bf16 v[88:91], a[20:23], v[208:211], v[88:91]
  ds_read_b64_tr_b16 a[58:59], v28 offset:51808
  v_mfma_f32_16x16x32_bf16 v[92:95], a[20:23], v[212:215], v[92:95]
  buffer_load_dwordx4 v35, s[56:59], s13 offen offset:2048 lds
  ds_read_b64_tr_b16 a[60:61], v28 offset:48256
  v_mfma_f32_16x16x32_bf16 v[96:99], a[24:27], v[208:211], v[96:99]
  ds_read_b64_tr_b16 a[62:63], v28 offset:51840
  ds_read_b64_tr_b16 a[64:65], v28 offset:48288
  v_mfma_f32_16x16x32_bf16 v[100:103], a[24:27], v[212:215], v[100:103]
  ds_read_b64_tr_b16 a[66:67], v28 offset:51872
  buffer_load_dwordx4 v36, s[56:59], s13 offen offset:3072 lds
  v_mfma_f32_16x16x32_bf16 v[104:107], a[28:31], v[208:211], v[104:107]
  ds_read_b64_tr_b16 a[68:69], v28 offset:48320
  v_mfma_f32_16x16x32_bf16 v[108:111], a[28:31], v[212:215], v[108:111]
  ds_read_b64_tr_b16 a[70:71], v28 offset:51904
  s_waitcnt lgkmcnt(14)
  v_mfma_f32_16x16x32_bf16 v[112:115], a[32:35], v[208:211], v[112:115]
  s_add_u32 m0, m0, 4096
  s_nop 0
  buffer_load_dwordx4 v37, s[56:59], s13 offen offset:0 lds
  ds_read_b64_tr_b16 a[72:73], v31 offset:48128
  v_mfma_f32_16x16x32_bf16 v[116:119], a[32:35], v[212:215], v[116:119]
  ds_read_b64_tr_b16 a[74:75], v31 offset:51712
  v_mfma_f32_16x16x32_bf16 a[0:3], a[36:39], v[44:47], a[0:3]
  ds_read_b64_tr_b16 a[76:77], v31 offset:48256
  v_mfma_f32_16x16x32_bf16 a[4:7], a[40:43], v[44:47], a[4:7]
  buffer_load_dwordx4 v38, s[56:59], s13 offen offset:1024 lds
  ds_read_b64_tr_b16 a[78:79], v31 offset:51840
  s_barrier
  s_waitcnt lgkmcnt(12)
  v_mfma_f32_16x16x32_bf16 v[64:67], a[44:47], v[216:219], v[64:67]
  ds_read_b64_tr_b16 a[8:9], v27 offset:22528
  ds_read_b64_tr_b16 a[10:11], v27 offset:26112
  v_mfma_f32_16x16x32_bf16 v[68:71], a[44:47], v[220:223], v[68:71]
  buffer_load_dwordx4 v39, s[56:59], s13 offen offset:2048 lds
  ds_read_b64_tr_b16 a[12:13], v27 offset:22560
  v_mfma_f32_16x16x32_bf16 v[72:75], a[48:51], v[216:219], v[72:75]
  ds_read_b64_tr_b16 a[14:15], v27 offset:26144
  v_mfma_f32_16x16x32_bf16 v[76:79], a[48:51], v[220:223], v[76:79]
  ds_read_b64_tr_b16 a[16:17], v27 offset:22592
  v_mfma_f32_16x16x32_bf16 v[80:83], a[52:55], v[216:219], v[80:83]
  buffer_load_dwordx4 v40, s[56:59], s13 offen offset:3072 lds
  s_add_u32 s13, s13, 512
  ds_read_b64_tr_b16 a[18:19], v27 offset:26176
  v_mfma_f32_16x16x32_bf16 v[84:87], a[52:55], v[220:223], v[84:87]
  ds_read_b64_tr_b16 a[20:21], v27 offset:22624
  s_waitcnt lgkmcnt(13)
  v_mfma_f32_16x16x32_bf16 v[88:91], a[56:59], v[216:219], v[88:91]
  s_waitcnt vmcnt(12)
  ds_read_b128 a[140:143], v48 offset:0
  ds_read_b128 a[172:175], v49 offset:0
  ds_read_b128 a[204:207], v50 offset:0
  ds_read_b128 a[236:239], v51 offset:0
  ds_read_b64_tr_b16 a[22:23], v27 offset:26208
  v_mfma_f32_16x16x32_bf16 v[92:95], a[56:59], v[220:223], v[92:95]
  ds_read_b64_tr_b16 a[24:25], v27 offset:22656
  v_mfma_f32_16x16x32_bf16 v[96:99], a[60:63], v[216:219], v[96:99]
  ds_read_b64_tr_b16 a[26:27], v27 offset:26240
  ds_read_b64_tr_b16 a[28:29], v27 offset:22688
  v_mfma_f32_16x16x32_bf16 v[100:103], a[60:63], v[220:223], v[100:103]
  s_waitcnt vmcnt(8)
  ds_read_b128 a[156:159], v48 offset:4096
  ds_read_b128 a[188:191], v49 offset:4096
  ds_read_b128 a[220:223], v50 offset:4096
  ds_read_b128 a[252:255], v51 offset:4096
  ds_read_b64_tr_b16 a[30:31], v27 offset:26272
  v_mfma_f32_16x16x32_bf16 v[104:107], a[64:67], v[216:219], v[104:107]
  ds_read_b64_tr_b16 a[32:33], v27 offset:22720
  v_mfma_f32_16x16x32_bf16 v[108:111], a[64:67], v[220:223], v[108:111]
  ds_read_b64_tr_b16 a[34:35], v27 offset:26304
  v_mov_b32 v62, 0
  buffer_load_dwordx2 v[54:55], v62, s[84:87], 0 offen sc1
  s_mul_i32 s14, s5, 224
  v_lshl_add_u32 v62, v3, 3, s14
  s_waitcnt lgkmcnt(15)
  v_mfma_f32_16x16x32_bf16 v[112:115], a[68:71], v[216:219], v[112:115]
  ds_read_b64_tr_b16 a[36:37], v30 offset:22528
  v_mfma_f32_16x16x32_bf16 v[116:119], a[68:71], v[220:223], v[116:119]
  ds_read_b64_tr_b16 a[38:39], v30 offset:26112
  v_mfma_f32_16x16x32_bf16 a[0:3], a[72:75], v[44:47], a[0:3]
  global_load_dwordx2 v[4:5], v62, s[38:39] offset:0
  global_load_dwordx2 v[6:7], v62, s[38:39] offset:32
  ds_read_b64_tr_b16 a[40:41], v30 offset:22656
  v_mfma_f32_16x16x32_bf16 a[4:7], a[76:79], v[44:47], a[4:7]
  ds_read_b64_tr_b16 a[42:43], v30 offset:26240
  v_mfma_f32_16x16x32_bf16 v[64:67], a[8:11], v[224:227], v[64:67]
  ds_read_b64_tr_b16 a[44:45], v27 offset:55296
  ds_read_b64_tr_b16 a[46:47], v27 offset:58880
  global_load_dwordx2 v[124:125], v62, s[38:39] offset:64
  global_load_dwordx2 v[126:127], v62, s[38:39] offset:96
  v_mfma_f32_16x16x32_bf16 v[68:71], a[8:11], v[228:231], v[68:71]
  ds_read_b64_tr_b16 a[48:49], v27 offset:55328
  v_mfma_f32_16x16x32_bf16 v[72:75], a[12:15], v[224:227], v[72:75]
  ds_read_b64_tr_b16 a[50:51], v27 offset:58912
  v_mfma_f32_16x16x32_bf16 v[76:79], a[12:15], v[228:231], v[76:79]
  global_load_dwordx2 v[48:49], v62, s[38:39] offset:128
  global_load_dwordx2 v[50:51], v62, s[38:39] offset:160
  ds_read_b64_tr_b16 a[52:53], v27 offset:55360
  v_mfma_f32_16x16x32_bf16 v[80:83], a[16:19], v[224:227], v[80:83]
  ds_read_b64_tr_b16 a[54:55], v27 offset:58944
  v_mfma_f32_16x16x32_bf16 v[84:87], a[16:19], v[228:231], v[84:87]
  ds_read_b64_tr_b16 a[56:57], v27 offset:55392
  s_waitcnt lgkmcnt(13)
  v_mfma_f32_16x16x32_bf16 v[88:91], a[20:23], v[224:227], v[88:91]
  global_load_dwordx2 v[52:53], v62, s[38:39] offset:192
  ds_read_b64_tr_b16 a[58:59], v27 offset:58976
  v_mfma_f32_16x16x32_bf16 v[92:95], a[20:23], v[228:231], v[92:95]
  ds_read_b64_tr_b16 a[60:61], v27 offset:55424
  v_mfma_f32_16x16x32_bf16 v[96:99], a[24:27], v[224:227], v[96:99]
  ds_read_b64_tr_b16 a[62:63], v27 offset:59008
  ds_read_b64_tr_b16 a[64:65], v27 offset:55456
  s_mov_b32 m0, s15
  s_nop 0
  buffer_load_dwordx4 v33, s[56:59], s13 offen offset:0 lds
  v_mfma_f32_16x16x32_bf16 v[100:103], a[24:27], v[228:231], v[100:103]
  ds_read_b64_tr_b16 a[66:67], v27 offset:59040
  v_mfma_f32_16x16x32_bf16 v[104:107], a[28:31], v[224:227], v[104:107]
  ds_read_b64_tr_b16 a[68:69], v27 offset:55488
  v_mfma_f32_16x16x32_bf16 v[108:111], a[28:31], v[228:231], v[108:111]
  buffer_load_dwordx4 v34, s[56:59], s13 offen offset:1024 lds
  ds_read_b64_tr_b16 a[70:71], v27 offset:59072
  s_waitcnt lgkmcnt(14)
  v_mfma_f32_16x16x32_bf16 v[112:115], a[32:35], v[224:227], v[112:115]
  ds_read_b64_tr_b16 a[72:73], v30 offset:55296
  v_mfma_f32_16x16x32_bf16 v[116:119], a[32:35], v[228:231], v[116:119]
  ds_read_b64_tr_b16 a[74:75], v30 offset:58880
  v_mfma_f32_16x16x32_bf16 a[0:3], a[36:39], v[44:47], a[0:3]
  buffer_load_dwordx4 v35, s[56:59], s13 offen offset:2048 lds
  ds_read_b64_tr_b16 a[76:77], v30 offset:55424
  v_mfma_f32_16x16x32_bf16 a[4:7], a[40:43], v[44:47], a[4:7]
  ds_read_b64_tr_b16 a[78:79], v30 offset:59008
  s_waitcnt lgkmcnt(12)
  v_mfma_f32_16x16x32_bf16 v[64:67], a[44:47], v[232:235], v[64:67]
  ds_read_b64_tr_b16 a[8:9], v28 offset:22528
  buffer_load_dwordx4 v36, s[56:59], s13 offen offset:3072 lds
  ds_read_b64_tr_b16 a[10:11], v28 offset:26112
  v_mfma_f32_16x16x32_bf16 v[68:71], a[44:47], v[236:239], v[68:71]
  ds_read_b64_tr_b16 a[12:13], v28 offset:22560
  v_mfma_f32_16x16x32_bf16 v[72:75], a[48:51], v[232:235], v[72:75]
  ds_read_b64_tr_b16 a[14:15], v28 offset:26144
  v_mfma_f32_16x16x32_bf16 v[76:79], a[48:51], v[236:239], v[76:79]
  s_add_u32 m0, m0, 4096
  s_nop 0
  buffer_load_dwordx4 v37, s[56:59], s13 offen offset:0 lds
  ds_read_b64_tr_b16 a[16:17], v28 offset:22592
  v_mfma_f32_16x16x32_bf16 v[80:83], a[52:55], v[232:235], v[80:83]
  ds_read_b64_tr_b16 a[18:19], v28 offset:26176
  v_mfma_f32_16x16x32_bf16 v[84:87], a[52:55], v[236:239], v[84:87]
  ds_read_b64_tr_b16 a[20:21], v28 offset:22624
  s_waitcnt lgkmcnt(13)
  buffer_load_dwordx4 v38, s[56:59], s13 offen offset:1024 lds
  v_mfma_f32_16x16x32_bf16 v[88:91], a[56:59], v[232:235], v[88:91]
  ds_read_b64_tr_b16 a[22:23], v28 offset:26208
  v_mfma_f32_16x16x32_bf16 v[92:95], a[56:59], v[236:239], v[92:95]
  ds_read_b64_tr_b16 a[24:25], v28 offset:22656
  v_mfma_f32_16x16x32_bf16 v[96:99], a[60:63], v[232:235], v[96:99]
  buffer_load_dwordx4 v39, s[56:59], s13 offen offset:2048 lds
  ds_read_b64_tr_b16 a[26:27], v28 offset:26240
  ds_read_b64_tr_b16 a[28:29], v28 offset:22688
  v_mfma_f32_16x16x32_bf16 v[100:103], a[60:63], v[236:239], v[100:103]
  ds_read_b64_tr_b16 a[30:31], v28 offset:26272
  v_mfma_f32_16x16x32_bf16 v[104:107], a[64:67], v[232:235], v[104:107]
  ds_read_b64_tr_b16 a[32:33], v28 offset:22720
  v_mfma_f32_16x16x32_bf16 v[108:111], a[64:67], v[236:239], v[108:111]
  buffer_load_dwordx4 v40, s[56:59], s13 offen offset:3072 lds
  ds_read_b64_tr_b16 a[34:35], v28 offset:26304
  s_waitcnt lgkmcnt(14)
  v_mfma_f32_16x16x32_bf16 v[112:115], a[68:71], v[232:235], v[112:115]
  ds_read_b64_tr_b16 a[36:37], v31 offset:22528
  v_mfma_f32_16x16x32_bf16 v[116:119], a[68:71], v[236:239], v[116:119]
  ds_read_b64_tr_b16 a[38:39], v31 offset:26112
  v_mfma_f32_16x16x32_bf16 a[0:3], a[72:75], v[44:47], a[0:3]
  ds_read_b64_tr_b16 a[40:41], v31 offset:22656
  v_mfma_f32_16x16x32_bf16 a[4:7], a[76:79], v[44:47], a[4:7]
  ds_read_b64_tr_b16 a[42:43], v31 offset:26240
  s_waitcnt lgkmcnt(12)
  v_mfma_f32_16x16x32_bf16 v[64:67], a[8:11], v[240:243], v[64:67]
  v_accvgpr_write_b32 a80, -1
  v_accvgpr_write_b32 a81, -1
  v_accvgpr_write_b32 a82, -1
  v_accvgpr_write_b32 a83, -1
  v_lshlrev_b32 v120, 4, v1
  ds_read_b64_tr_b16 a[44:45], v28 offset:55296
  ds_read_b64_tr_b16 a[46:47], v28 offset:58880
  v_mfma_f32_16x16x32_bf16 v[68:71], a[8:11], v[244:247], v[68:71]
  ds_read_b64_tr_b16 a[48:49], v28 offset:55328
  v_mfma_f32_16x16x32_bf16 v[72:75], a[12:15], v[240:243], v[72:75]
  ds_read_b64_tr_b16 a[50:51], v28 offset:58912
  buffer_store_dwordx4 a[80:83], v120, s[64:67], s100 offen offset:0 sc1
  v_mfma_f32_16x16x32_bf16 v[76:79], a[12:15], v[244:247], v[76:79]
  ds_read_b64_tr_b16 a[52:53], v28 offset:55360
  v_mfma_f32_16x16x32_bf16 v[80:83], a[16:19], v[240:243], v[80:83]
  ds_read_b64_tr_b16 a[54:55], v28 offset:58944
  v_mfma_f32_16x16x32_bf16 v[84:87], a[16:19], v[244:247], v[84:87]
  buffer_store_dwordx4 a[80:83], v120, s[64:67], s100 offen offset:1024 sc1
  ds_read_b64_tr_b16 a[56:57], v28 offset:55392
  s_waitcnt lgkmcnt(13)
  v_mfma_f32_16x16x32_bf16 v[88:91], a[20:23], v[240:243], v[88:91]
  ds_read_b64_tr_b16 a[58:59], v28 offset:58976
  v_mfma_f32_16x16x32_bf16 v[92:95], a[20:23], v[244:247], v[92:95]
  ds_read_b64_tr_b16 a[60:61], v28 offset:55424
  v_mfma_f32_16x16x32_bf16 v[96:99], a[24:27], v[240:243], v[96:99]
  buffer_store_dwordx4 a[80:83], v120, s[64:67], s100 offen offset:2048 sc1
  ds_read_b64_tr_b16 a[62:63], v28 offset:59008
  ds_read_b64_tr_b16 a[64:65], v28 offset:55456
  v_mfma_f32_16x16x32_bf16 v[100:103], a[24:27], v[244:247], v[100:103]
  ds_read_b64_tr_b16 a[66:67], v28 offset:59040
  v_mfma_f32_16x16x32_bf16 v[104:107], a[28:31], v[240:243], v[104:107]
  ds_read_b64_tr_b16 a[68:69], v28 offset:55488
  buffer_store_dwordx4 a[80:83], v120, s[64:67], s100 offen offset:3072 sc1
  v_mfma_f32_16x16x32_bf16 v[108:111], a[28:31], v[244:247], v[108:111]
  ds_read_b64_tr_b16 a[70:71], v28 offset:59072
  s_waitcnt lgkmcnt(14)
  v_mfma_f32_16x16x32_bf16 v[112:115], a[32:35], v[240:243], v[112:115]
  ds_read_b64_tr_b16 a[72:73], v31 offset:55296
  v_mfma_f32_16x16x32_bf16 v[116:119], a[32:35], v[244:247], v[116:119]
  ds_read_b64_tr_b16 a[74:75], v31 offset:58880
  v_mfma_f32_16x16x32_bf16 a[0:3], a[36:39], v[44:47], a[0:3]
  ds_read_b64_tr_b16 a[76:77], v31 offset:55424
  v_mfma_f32_16x16x32_bf16 a[4:7], a[40:43], v[44:47], a[4:7]
  ds_read_b64_tr_b16 a[78:79], v31 offset:59008
  s_waitcnt lgkmcnt(0)
  v_mfma_f32_16x16x32_bf16 a[0:3], a[72:75], v[44:47], a[0:3]
  v_mfma_f32_16x16x32_bf16 a[4:7], a[76:79], v[44:47], a[4:7]
  v_lshlrev_b32 v61, 4, v3
  v_add_u32 v62, s8, v61
  v_add_u32 v63, 0x10000, v61
  s_nop 4
  ds_write_b128 v62, a[0:3] offset:32000
  ds_write_b128 v62, a[4:7] offset:32064
  s_waitcnt lgkmcnt(0)
  s_waitcnt vmcnt(20)
  s_barrier
  v_lshrrev_b32 v21, 3, v1
  v_and_b32 v22, 6, v21
  v_and_b32 v20, 7, v1
  v_xor_b32 v20, v20, v22
  v_lshlrev_b32 v20, 4, v20
  v_lshl_add_u32 v20, v21, 10, v20
  v_add_u32 v41, 7168, v20
  s_add_u32 m0, s8, 8192
  s_add_u32 s14, s9, 0
  buffer_load_dwordx4 v20, s[76:79], s14 offen offset:0 lds
  ds_read_b128 v[120:123], v61 offset:32000
  v_mfma_f32_16x16x32_bf16 v[64:67], a[44:47], v[248:251], v[64:67]
  v_mfma_f32_16x16x32_bf16 v[68:71], a[44:47], v[252:255], v[68:71]
  v_mfma_f32_16x16x32_bf16 v[72:75], a[48:51], v[248:251], v[72:75]
  v_mfma_f32_16x16x32_bf16 v[76:79], a[48:51], v[252:255], v[76:79]
  v_mfma_f32_16x16x32_bf16 v[80:83], a[52:55], v[248:251], v[80:83]
  v_mfma_f32_16x16x32_bf16 v[84:87], a[52:55], v[252:255], v[84:87]
  v_mfma_f32_16x16x32_bf16 v[88:91], a[56:59], v[248:251], v[88:91]
  v_mfma_f32_16x16x32_bf16 v[92:95], a[56:59], v[252:255], v[92:95]
  buffer_load_dwordx4 v41, s[76:79], s14 offen offset:1024 lds
  v_mfma_f32_16x16x32_bf16 v[96:99], a[60:63], v[248:251], v[96:99]
  v_mfma_f32_16x16x32_bf16 v[100:103], a[60:63], v[252:255], v[100:103]
  v_mfma_f32_16x16x32_bf16 v[104:107], a[64:67], v[248:251], v[104:107]
  v_mfma_f32_16x16x32_bf16 v[108:111], a[64:67], v[252:255], v[108:111]
  v_mfma_f32_16x16x32_bf16 v[112:115], a[68:71], v[248:251], v[112:115]
  v_mfma_f32_16x16x32_bf16 v[116:119], a[68:71], v[252:255], v[116:119]
  v_add_u32 v33, s8, v8
  v_add_u32 v34, s8, v9
  v_add_u32 v35, s8, v10
  v_add_u32 v36, s8, v11
  s_add_u32 s14, s9, 14336
  buffer_load_dwordx4 v20, s[76:79], s14 offen offset:2048 lds
  v_lshlrev_b32 v29, 4, v1
  s_add_u32 s12, s100, 4096
  s_waitcnt vmcnt(15)
  v_and_b32 v31, 0xffff0000, v4
  v_lshlrev_b32 v30, 16, v4
  v_and_b32 v60, 0xffff0000, v5
  v_lshlrev_b32 v32, 16, v5
  ds_read_b128 v[22:25], v61 offset:64768
  s_waitcnt lgkmcnt(1)
  v_fma_f32 v64, -v56, v120, v64
  v_fma_f32 v65, -v56, v121, v65
  v_fma_f32 v66, -v56, v122, v66
  v_fma_f32 v67, -v56, v123, v67
  v_fma_f32 v64, v64, v57, v30
  v_fma_f32 v65, v65, v57, v31
  v_fma_f32 v66, v66, v57, v32
  v_fma_f32 v67, v67, v57, v60
  v_max_f32 v64, 0, v64
  v_max_f32 v65, 0, v65
  v_max_f32 v66, 0, v66
  v_max_f32 v67, 0, v67
  v_mul_f32 v64, v64, v64
  v_mul_f32 v65, v65, v65
  v_mul_f32 v66, v66, v66
  v_mul_f32 v67, v67, v67
  buffer_load_dwordx4 v41, s[76:79], s14 offen offset:3072 lds
  v_cvt_pk_bf16_f32 v64, v64, v65
  v_cvt_pk_bf16_f32 v65, v66, v67
  v_fma_f32 v68, -v58, v120, v68
  v_fma_f32 v69, -v58, v121, v69
  v_fma_f32 v70, -v58, v122, v70
  v_fma_f32 v71, -v58, v123, v71
  v_fma_f32 v68, v68, v59, v30
  v_fma_f32 v69, v69, v59, v31
  v_fma_f32 v70, v70, v59, v32
  v_fma_f32 v71, v71, v59, v60
  v_max_f32 v68, 0, v68
  v_max_f32 v69, 0, v69
  v_max_f32 v70, 0, v70
  v_max_f32 v71, 0, v71
  v_mul_f32 v68, v68, v68
  v_mul_f32 v69, v69, v69
  v_mul_f32 v70, v70, v70
  v_mul_f32 v71, v71, v71
  v_cvt_pk_bf16_f32 v68, v68, v69
  v_cvt_pk_bf16_f32 v69, v70, v71
  v_and_b32 v31, 0xffff0000, v6
  v_lshlrev_b32 v30, 16, v6
  v_and_b32 v60, 0xffff0000, v7
  v_lshlrev_b32 v32, 16, v7
  s_add_u32 m0, s8, 12288
  s_add_u32 s14, s9, 32768
  buffer_load_dwordx4 v20, s[76:79], s14 offen offset:0 lds
  ds_read_b128 v[120:123], v63 offset:32000
  s_waitcnt lgkmcnt(1)
  v_fma_f32 v72, -v56, v22, v72
  v_fma_f32 v73, -v56, v23, v73
  v_fma_f32 v74, -v56, v24, v74
  v_fma_f32 v75, -v56, v25, v75
  v_fma_f32 v72, v72, v57, v30
  v_fma_f32 v73, v73, v57, v31
  v_fma_f32 v74, v74, v57, v32
  v_fma_f32 v75, v75, v57, v60
  v_max_f32 v72, 0, v72
  v_max_f32 v73, 0, v73
  v_max_f32 v74, 0, v74
  v_max_f32 v75, 0, v75
  v_mul_f32 v72, v72, v72
  v_mul_f32 v73, v73, v73
  v_mul_f32 v74, v74, v74
  v_mul_f32 v75, v75, v75
  v_cvt_pk_bf16_f32 v66, v72, v73
  v_cvt_pk_bf16_f32 v67, v74, v75
  buffer_store_dwordx4 v[64:67], v29, s[64:67], s12 offen offset:0 sc1
  v_fma_f32 v76, -v58, v22, v76
  v_fma_f32 v77, -v58, v23, v77
  v_fma_f32 v78, -v58, v24, v78
  v_fma_f32 v79, -v58, v25, v79
  v_fma_f32 v76, v76, v59, v30
  v_fma_f32 v77, v77, v59, v31
  v_fma_f32 v78, v78, v59, v32
  v_fma_f32 v79, v79, v59, v60
  v_max_f32 v76, 0, v76
  v_max_f32 v77, 0, v77
  v_max_f32 v78, 0, v78
  v_max_f32 v79, 0, v79
  v_mul_f32 v76, v76, v76
  v_mul_f32 v77, v77, v77
  buffer_load_dwordx4 v41, s[76:79], s14 offen offset:1024 lds
  v_mul_f32 v78, v78, v78
  v_mul_f32 v79, v79, v79
  v_cvt_pk_bf16_f32 v70, v76, v77
  v_cvt_pk_bf16_f32 v71, v78, v79
  buffer_store_dwordx4 v[68:71], v29, s[64:67], s12 offen offset:1024 sc1
  s_add_u32 s12, s12, 2048
  v_and_b32 v31, 0xffff0000, v124
  v_lshlrev_b32 v30, 16, v124
  v_and_b32 v60, 0xffff0000, v125
  v_lshlrev_b32 v32, 16, v125
  ds_read_b128 v[22:25], v63 offset:64768
  s_waitcnt lgkmcnt(1)
  v_fma_f32 v80, -v56, v120, v80
  v_fma_f32 v81, -v56, v121, v81
  v_fma_f32 v82, -v56, v122, v82
  v_fma_f32 v83, -v56, v123, v83
  v_fma_f32 v80, v80, v57, v30
  v_fma_f32 v81, v81, v57, v31
  v_fma_f32 v82, v82, v57, v32
  v_fma_f32 v83, v83, v57, v60
  v_max_f32 v80, 0, v80
  v_max_f32 v81, 0, v81
  v_max_f32 v82, 0, v82
  v_max_f32 v83, 0, v83
  v_mul_f32 v80, v80, v80
  v_mul_f32 v81, v81, v81
  v_mul_f32 v82, v82, v82
  v_mul_f32 v83, v83, v83
  v_cvt_pk_bf16_f32 v80, v80, v81
  v_cvt_pk_bf16_f32 v81, v82, v83
  v_fma_f32 v84, -v58, v120, v84
  v_fma_f32 v85, -v58, v121, v85
  v_fma_f32 v86, -v58, v122, v86
  v_fma_f32 v87, -v58, v123, v87
  v_fma_f32 v84, v84, v59, v30
  v_fma_f32 v85, v85, v59, v31
  s_add_u32 s14, s9, 47104
  buffer_load_dwordx4 v20, s[76:79], s14 offen offset:2048 lds
  v_fma_f32 v86, v86, v59, v32
  v_fma_f32 v87, v87, v59, v60
  v_max_f32 v84, 0, v84
  v_max_f32 v85, 0, v85
  v_max_f32 v86, 0, v86
  v_max_f32 v87, 0, v87
  v_mul_f32 v84, v84, v84
  v_mul_f32 v85, v85, v85
  v_mul_f32 v86, v86, v86
  v_mul_f32 v87, v87, v87
  v_cvt_pk_bf16_f32 v84, v84, v85
  v_cvt_pk_bf16_f32 v85, v86, v87
  v_and_b32 v31, 0xffff0000, v126
  v_lshlrev_b32 v30, 16, v126
  v_and_b32 v60, 0xffff0000, v127
  v_lshlrev_b32 v32, 16, v127
  ds_read_b128 v[120:123], v61 offset:32064
  s_waitcnt lgkmcnt(1)
  v_fma_f32 v88, -v56, v22, v88
  v_fma_f32 v89, -v56, v23, v89
  v_fma_f32 v90, -v56, v24, v90
  v_fma_f32 v91, -v56, v25, v91
  v_fma_f32 v88, v88, v57, v30
  v_fma_f32 v89, v89, v57, v31
  buffer_load_dwordx4 v41, s[76:79], s14 offen offset:3072 lds
  v_fma_f32 v90, v90, v57, v32
  v_fma_f32 v91, v91, v57, v60
  v_max_f32 v88, 0, v88
  v_max_f32 v89, 0, v89
  v_max_f32 v90, 0, v90
  v_max_f32 v91, 0, v91
  v_mul_f32 v88, v88, v88
  v_mul_f32 v89, v89, v89
  v_mul_f32 v90, v90, v90
  v_mul_f32 v91, v91, v91
  v_cvt_pk_bf16_f32 v82, v88, v89
  v_cvt_pk_bf16_f32 v83, v90, v91
  buffer_store_dwordx4 v[80:83], v29, s[64:67], s12 offen offset:0 sc1
  v_fma_f32 v92, -v58, v22, v92
  v_fma_f32 v93, -v58, v23, v93
  v_fma_f32 v94, -v58, v24, v94
  v_fma_f32 v95, -v58, v25, v95
  v_fma_f32 v92, v92, v59, v30
  v_fma_f32 v93, v93, v59, v31
  v_fma_f32 v94, v94, v59, v32
  v_fma_f32 v95, v95, v59, v60
  v_max_f32 v92, 0, v92
  v_max_f32 v93, 0, v93
  v_max_f32 v94, 0, v94
  v_max_f32 v95, 0, v95
  v_mul_f32 v92, v92, v92
  v_mul_f32 v93, v93, v93
  v_mul_f32 v94, v94, v94
  v_mul_f32 v95, v95, v95
  v_cvt_pk_bf16_f32 v86, v92, v93
  v_cvt_pk_bf16_f32 v87, v94, v95
  buffer_store_dwordx4 v[84:87], v29, s[64:67], s12 offen offset:1024 sc1
  s_add_u32 s12, s12, 2048
  v_and_b32 v31, 0xffff0000, v48
  v_lshlrev_b32 v30, 16, v48
  v_and_b32 v60, 0xffff0000, v49
  v_lshlrev_b32 v32, 16, v49
  ds_read_b128 v[22:25], v61 offset:64832
  s_waitcnt lgkmcnt(1)
  v_fma_f32 v96, -v56, v120, v96
  v_fma_f32 v97, -v56, v121, v97
  v_fma_f32 v98, -v56, v122, v98
  v_fma_f32 v99, -v56, v123, v99
  v_fma_f32 v96, v96, v57, v30
  v_fma_f32 v97, v97, v57, v31
  v_fma_f32 v98, v98, v57, v32
  v_fma_f32 v99, v99, v57, v60
  s_add_u32 m0, s8, 16384
  s_add_u32 s14, s9, 65536
  buffer_load_dwordx4 v20, s[76:79], s14 offen offset:0 lds
  v_max_f32 v96, 0, v96
  v_max_f32 v97, 0, v97
  v_max_f32 v98, 0, v98
  v_max_f32 v99, 0, v99
  v_mul_f32 v96, v96, v96
  v_mul_f32 v97, v97, v97
  v_mul_f32 v98, v98, v98
  v_mul_f32 v99, v99, v99
  v_cvt_pk_bf16_f32 v96, v96, v97
  v_cvt_pk_bf16_f32 v97, v98, v99
  v_fma_f32 v100, -v58, v120, v100
  v_fma_f32 v101, -v58, v121, v101
  v_fma_f32 v102, -v58, v122, v102
  v_fma_f32 v103, -v58, v123, v103
  v_fma_f32 v100, v100, v59, v30
  v_fma_f32 v101, v101, v59, v31
  v_fma_f32 v102, v102, v59, v32
  v_fma_f32 v103, v103, v59, v60
  v_max_f32 v100, 0, v100
  v_max_f32 v101, 0, v101
  v_max_f32 v102, 0, v102
  v_max_f32 v103, 0, v103
  v_mul_f32 v100, v100, v100
  v_mul_f32 v101, v101, v101
  buffer_load_dwordx4 v41, s[76:79], s14 offen offset:1024 lds
  v_mul_f32 v102, v102, v102
  v_mul_f32 v103, v103, v103
  v_cvt_pk_bf16_f32 v100, v100, v101
  v_cvt_pk_bf16_f32 v101, v102, v103
  v_and_b32 v31, 0xffff0000, v50
  v_lshlrev_b32 v30, 16, v50
  v_and_b32 v60, 0xffff0000, v51
  v_lshlrev_b32 v32, 16, v51
  ds_read_b128 v[120:123], v63 offset:32064
  s_waitcnt lgkmcnt(1)
  v_fma_f32 v104, -v56, v22, v104
  v_fma_f32 v105, -v56, v23, v105
  v_fma_f32 v106, -v56, v24, v106
  v_fma_f32 v107, -v56, v25, v107
  v_fma_f32 v104, v104, v57, v30
  v_fma_f32 v105, v105, v57, v31
  v_fma_f32 v106, v106, v57, v32
  v_fma_f32 v107, v107, v57, v60
  v_max_f32 v104, 0, v104
  v_max_f32 v105, 0, v105
  v_max_f32 v106, 0, v106
  v_max_f32 v107, 0, v107
  v_mul_f32 v104, v104, v104
  v_mul_f32 v105, v105, v105
  s_add_u32 s14, s9, 79872
  buffer_load_dwordx4 v20, s[76:79], s14 offen offset:2048 lds
  v_mul_f32 v106, v106, v106
  v_mul_f32 v107, v107, v107
  v_cvt_pk_bf16_f32 v98, v104, v105
  v_cvt_pk_bf16_f32 v99, v106, v107
  buffer_store_dwordx4 v[96:99], v29, s[64:67], s12 offen offset:0 sc1
  v_fma_f32 v108, -v58, v22, v108
  v_fma_f32 v109, -v58, v23, v109
  v_fma_f32 v110, -v58, v24, v110
  v_fma_f32 v111, -v58, v25, v111
  v_fma_f32 v108, v108, v59, v30
  v_fma_f32 v109, v109, v59, v31
  v_fma_f32 v110, v110, v59, v32
  v_fma_f32 v111, v111, v59, v60
  v_max_f32 v108, 0, v108
  v_max_f32 v109, 0, v109
  v_max_f32 v110, 0, v110
  v_max_f32 v111, 0, v111
  v_mul_f32 v108, v108, v108
  v_mul_f32 v109, v109, v109
  v_mul_f32 v110, v110, v110
  v_mul_f32 v111, v111, v111
  v_cvt_pk_bf16_f32 v102, v108, v109
  v_cvt_pk_bf16_f32 v103, v110, v111
  buffer_store_dwordx4 v[100:103], v29, s[64:67], s12 offen offset:1024 sc1
  s_add_u32 s12, s12, 2048
  ds_read_b128 a[8:11], v8 offset:0
  ds_read_b128 a[12:15], v8 offset:32768
  ds_read_b128 a[16:19], v12 offset:0
  ds_read_b128 a[20:23], v12 offset:32768
  ds_read_b128 a[24:27], v33 offset:0
  v_and_b32 v31, 0xffff0000, v52
  v_lshlrev_b32 v30, 16, v52
  v_and_b32 v60, 0xffff0000, v53
  v_lshlrev_b32 v32, 16, v53
  s_waitcnt lgkmcnt(5)
  v_fma_f32 v112, -v56, v120, v112
  v_fma_f32 v113, -v56, v121, v113
  v_fma_f32 v114, -v56, v122, v114
  v_fma_f32 v115, -v56, v123, v115
  v_fma_f32 v112, v112, v57, v30
  v_fma_f32 v113, v113, v57, v31
  v_fma_f32 v114, v114, v57, v32
  v_fma_f32 v115, v115, v57, v60
  v_max_f32 v112, 0, v112
  v_max_f32 v113, 0, v113
  v_max_f32 v114, 0, v114
  v_max_f32 v115, 0, v115
  buffer_load_dwordx4 v41, s[76:79], s14 offen offset:3072 lds
  v_mul_f32 v112, v112, v112
  v_mul_f32 v113, v113, v113
  v_mul_f32 v114, v114, v114
  v_mul_f32 v115, v115, v115
  v_cvt_pk_bf16_f32 v112, v112, v113
  v_cvt_pk_bf16_f32 v113, v114, v115
  v_fma_f32 v116, -v58, v120, v116
  v_fma_f32 v117, -v58, v121, v117
  v_fma_f32 v118, -v58, v122, v118
  v_fma_f32 v119, -v58, v123, v119
  v_fma_f32 v116, v116, v59, v30
  v_fma_f32 v117, v117, v59, v31
  v_fma_f32 v118, v118, v59, v32
  v_fma_f32 v119, v119, v59, v60
  v_max_f32 v116, 0, v116
  v_max_f32 v117, 0, v117
  v_max_f32 v118, 0, v118
  v_max_f32 v119, 0, v119
  v_mul_f32 v116, v116, v116
  v_mul_f32 v117, v117, v117
  v_mul_f32 v118, v118, v118
  v_mul_f32 v119, v119, v119
  v_cvt_pk_bf16_f32 v114, v116, v117
  v_cvt_pk_bf16_f32 v115, v118, v119
  buffer_store_dwordx4 v[112:115], v29, s[64:67], s12 offen sc1
  v_lshlrev_b32 v4, 4, v2
  buffer_store_dwordx4 v[56:59], v4, s[64:67], s12 offen offset:1024 sc1
  v_lshrrev_b32 v25, 2, v1
  v_bfe_u32 v26, v1, 3, 2
  v_and_b32 v27, 3, v1
  v_lshlrev_b32 v27, 3, v27
  v_lshl_add_u32 v27, v25, 7, v27
  v_add_u32 v27, s8, v27
  s_mul_i32 s15, s3, 24576
  s_sub_u32 s15, 131072, s15
  v_xor_b32 v25, 0, v26
  v_lshl_add_u32 v21, v25, 5, v27
  v_add_u32 v48, s15, v21
  v_xor_b32 v25, 1, v26
  v_lshl_add_u32 v22, v25, 5, v27
  v_add_u32 v49, s15, v22
  v_xor_b32 v25, 2, v26
  v_lshl_add_u32 v23, v25, 5, v27
  v_add_u32 v50, s15, v23
  v_xor_b32 v25, 3, v26
  v_lshl_add_u32 v24, v25, 5, v27
  v_add_u32 v51, s15, v24
  s_lshl_b32 s15, s98, 10
  v_add_u32 v25, s15, v29
  v_xor_b32 v26, 1024, v25
  s_lshl_b32 s15, s98, 3
  v_add_u32 v27, s15, v29
  v_xor_b32 v28, 8, v27
  v_bfe_u32 v37, v1, 2, 1
  v_and_b32 v38, 3, v1
  v_lshl_add_u32 v37, v37, 4, v38
  v_lshlrev_b32 v37, 7, v37
  s_add_u32 m0, s8, 20480
  s_add_u32 s14, s9, 114688
  buffer_load_dwordx4 v20, s[76:79], s14 offen offset:0 lds
  s_waitcnt lgkmcnt(3)
  v_mfma_f32_16x16x32_bf16 v[96:99], a[8:11], v[128:131], 0
  ds_read_b128 a[28:31], v9 offset:0
  v_mfma_f32_16x16x32_bf16 v[100:103], a[8:11], v[132:135], 0
  ds_read_b128 a[32:35], v9 offset:32768
  v_mfma_f32_16x16x32_bf16 v[104:107], a[12:15], v[128:131], 0
  v_mfma_f32_16x16x32_bf16 v[108:111], a[12:15], v[132:135], 0
  buffer_load_dwordx4 v41, s[76:79], s14 offen offset:1024 lds
  ds_read_b128 a[36:39], v13 offset:0
  s_waitcnt lgkmcnt(3)
  v_mfma_f32_16x16x32_bf16 v[112:115], a[16:19], v[128:131], 0
  v_mfma_f32_16x16x32_bf16 v[116:119], a[16:19], v[132:135], 0
  ds_read_b128 a[40:43], v13 offset:32768
  v_mfma_f32_16x16x32_bf16 v[120:123], a[20:23], v[128:131], 0
  s_add_u32 s14, s9, 129024
  buffer_load_dwordx4 v20, s[76:79], s14 offen offset:2048 lds
  v_mfma_f32_16x16x32_bf16 v[124:127], a[20:23], v[132:135], 0
  ds_read_b128 a[44:47], v34 offset:0
  v_mfma_f32_16x16x32_bf16 a[0:3], a[24:27], v[44:47], 0
  s_waitcnt lgkmcnt(3)
  v_mfma_f32_16x16x32_bf16 v[96:99], a[28:31], v[136:139], v[96:99]
  ds_read_b128 a[8:11], v10 offset:0
  v_mfma_f32_16x16x32_bf16 v[100:103], a[28:31], v[140:143], v[100:103]
  buffer_load_dwordx4 v41, s[76:79], s14 offen offset:3072 lds
  ds_read_b128 a[12:15], v10 offset:32768
  v_mfma_f32_16x16x32_bf16 v[104:107], a[32:35], v[136:139], v[104:107]
  v_mfma_f32_16x16x32_bf16 v[108:111], a[32:35], v[140:143], v[108:111]
  ds_read_b128 a[16:19], v14 offset:0
  s_waitcnt lgkmcnt(3)
  v_mfma_f32_16x16x32_bf16 v[112:115], a[36:39], v[136:139], v[112:115]
  s_add_u32 m0, s8, 24576
  s_add_u32 s14, s9, 147456
  buffer_load_dwordx4 v20, s[76:79], s14 offen offset:0 lds
  v_mfma_f32_16x16x32_bf16 v[116:119], a[36:39], v[140:143], v[116:119]
  ds_read_b128 a[20:23], v14 offset:32768
  v_mfma_f32_16x16x32_bf16 v[120:123], a[40:43], v[136:139], v[120:123]
  v_mfma_f32_16x16x32_bf16 v[124:127], a[40:43], v[140:143], v[124:127]
  ds_read_b128 a[24:27], v35 offset:0
  v_mfma_f32_16x16x32_bf16 a[0:3], a[44:47], v[44:47], a[0:3]
  buffer_load_dwordx4 v41, s[76:79], s14 offen offset:1024 lds
  s_waitcnt lgkmcnt(3)
  v_mfma_f32_16x16x32_bf16 v[96:99], a[8:11], v[144:147], v[96:99]
  ds_read_b128 a[28:31], v11 offset:0
  v_mfma_f32_16x16x32_bf16 v[100:103], a[8:11], v[148:151], v[100:103]
  ds_read_b128 a[32:35], v11 offset:32768
  v_mfma_f32_16x16x32_bf16 v[104:107], a[12:15], v[144:147], v[104:107]
  v_mfma_f32_16x16x32_bf16 v[108:111], a[12:15], v[148:151], v[108:111]
  s_add_u32 s14, s9, 161792
  buffer_load_dwordx4 v20, s[76:79], s14 offen offset:2048 lds
  ds_read_b128 a[36:39], v15 offset:0
  s_waitcnt lgkmcnt(3)
  v_mfma_f32_16x16x32_bf16 v[112:115], a[16:19], v[144:147], v[112:115]
  v_mfma_f32_16x16x32_bf16 v[116:119], a[16:19], v[148:151], v[116:119]
  ds_read_b128 a[40:43], v15 offset:32768
  v_mfma_f32_16x16x32_bf16 v[120:123], a[20:23], v[144:147], v[120:123]
  buffer_load_dwordx4 v41, s[76:79], s14 offen offset:3072 lds
  v_mfma_f32_16x16x32_bf16 v[124:127], a[20:23], v[148:151], v[124:127]
  ds_read_b128 a[44:47], v36 offset:0
  v_mfma_f32_16x16x32_bf16 a[0:3], a[24:27], v[44:47], a[0:3]
  s_waitcnt lgkmcnt(3)
  v_mfma_f32_16x16x32_bf16 v[96:99], a[28:31], v[152:155], v[96:99]
  ds_read_b128 a[8:11], v8 offset:256
  v_mfma_f32_16x16x32_bf16 v[100:103], a[28:31], v[156:159], v[100:103]
  s_waitcnt vmcnt(24)
  ds_read_b64_tr_b16 a[64:65], v21 offset:8192
  ds_read_b64_tr_b16 a[66:67], v21 offset:10240
  ds_read_b64_tr_b16 a[68:69], v22 offset:8192
  ds_read_b64_tr_b16 a[70:71], v22 offset:10240
  ds_read_b128 a[12:15], v8 offset:33024
  v_mfma_f32_16x16x32_bf16 v[104:107], a[32:35], v[152:155], v[104:107]
  v_mfma_f32_16x16x32_bf16 v[108:111], a[32:35], v[156:159], v[108:111]
  ds_read_b128 a[16:19], v12 offset:256
  s_waitcnt lgkmcnt(7)
  v_mfma_f32_16x16x32_bf16 v[112:115], a[36:39], v[152:155], v[112:115]
  ds_read_b64_tr_b16 a[72:73], v23 offset:8192
  ds_read_b64_tr_b16 a[74:75], v23 offset:10240
  ds_read_b64_tr_b16 a[76:77], v24 offset:8192
  ds_read_b64_tr_b16 a[78:79], v24 offset:10240
  v_mfma_f32_16x16x32_bf16 v[116:119], a[36:39], v[156:159], v[116:119]
  ds_read_b128 a[20:23], v12 offset:33024
  v_mfma_f32_16x16x32_bf16 v[120:123], a[40:43], v[152:155], v[120:123]
  v_mfma_f32_16x16x32_bf16 v[124:127], a[40:43], v[156:159], v[124:127]
  ds_read_b128 a[24:27], v33 offset:256
  v_mfma_f32_16x16x32_bf16 a[0:3], a[44:47], v[44:47], a[0:3]
  s_waitcnt vmcnt(18)
  ds_read_b64_tr_b16 a[80:81], v21 offset:12288
  ds_read_b64_tr_b16 a[82:83], v21 offset:14336
  ds_read_b64_tr_b16 a[84:85], v22 offset:12288
  ds_read_b64_tr_b16 a[86:87], v22 offset:14336
  s_waitcnt lgkmcnt(11)
  v_mfma_f32_16x16x32_bf16 v[96:99], a[8:11], v[160:163], v[96:99]
  ds_read_b128 a[28:31], v9 offset:256
  v_mfma_f32_16x16x32_bf16 v[100:103], a[8:11], v[164:167], v[100:103]
  ds_read_b128 a[32:35], v9 offset:33024
  v_mfma_f32_16x16x32_bf16 v[104:107], a[12:15], v[160:163], v[104:107]
  ds_read_b64_tr_b16 a[88:89], v23 offset:12288
  ds_read_b64_tr_b16 a[90:91], v23 offset:14336
  ds_read_b64_tr_b16 a[92:93], v24 offset:12288
  ds_read_b64_tr_b16 a[94:95], v24 offset:14336
  v_mfma_f32_16x16x32_bf16 v[108:111], a[12:15], v[164:167], v[108:111]
  ds_read_b128 a[36:39], v13 offset:256
  s_waitcnt lgkmcnt(11)
  v_mfma_f32_16x16x32_bf16 v[112:115], a[16:19], v[160:163], v[112:115]
  v_mfma_f32_16x16x32_bf16 v[116:119], a[16:19], v[164:167], v[116:119]
  ds_read_b128 a[40:43], v13 offset:33024
  v_mfma_f32_16x16x32_bf16 v[120:123], a[20:23], v[160:163], v[120:123]
  s_add_u32 m0, s8, 8192
  s_add_u32 s14, s9, 180224
  buffer_load_dwordx4 v20, s[76:79], s14 offen offset:0 lds
  v_mfma_f32_16x16x32_bf16 v[124:127], a[20:23], v[164:167], v[124:127]
  ds_read_b128 a[44:47], v34 offset:256
  v_mfma_f32_16x16x32_bf16 a[0:3], a[24:27], v[44:47], a[0:3]
  s_waitcnt lgkmcnt(7)
  v_mfma_f32_16x16x32_bf16 v[96:99], a[28:31], v[168:171], v[96:99]
  ds_read_b128 a[8:11], v10 offset:256
  buffer_load_dwordx4 v41, s[76:79], s14 offen offset:1024 lds
  v_mfma_f32_16x16x32_bf16 v[100:103], a[28:31], v[172:175], v[100:103]
  ds_read_b128 a[12:15], v10 offset:33024
  v_mfma_f32_16x16x32_bf16 v[104:107], a[32:35], v[168:171], v[104:107]
  v_mfma_f32_16x16x32_bf16 v[108:111], a[32:35], v[172:175], v[108:111]
  ds_read_b128 a[16:19], v14 offset:256
  s_waitcnt lgkmcnt(3)
  v_mfma_f32_16x16x32_bf16 v[112:115], a[36:39], v[168:171], v[112:115]
  s_mov_b32 s50, 0
Ltag:
  v_readfirstlane_b32 s88, v54
  v_readfirstlane_b32 s89, v55
  s_nop 0
  s_cmp_lg_u32 s89, 0
  s_cbranch_scc1 Ltagok
  v_mov_b32 v4, 0
  buffer_load_dwordx2 v[54:55], v4, s[84:87], 0 offen sc1
  s_add_u32 s50, s50, 1
  s_waitcnt vmcnt(0)
  s_cmp_lt_u32 s50, 0x40000
  s_cbranch_scc1 Ltag
Ltagok:
  v_mov_b32 v4, 0
  s_waitcnt vmcnt(10)
  buffer_store_dwordx2 v[54:55], v4, s[64:67], s101 offen sc1
  v_mfma_f32_16x16x32_bf16 v[116:119], a[36:39], v[172:175], v[116:119]
  ds_read_b128 a[20:23], v14 offset:33024
  v_mfma_f32_16x16x32_bf16 v[120:123], a[40:43], v[168:171], v[120:123]
  v_mfma_f32_16x16x32_bf16 v[124:127], a[40:43], v[172:175], v[124:127]
  ds_read_b128 a[24:27], v35 offset:256
  s_add_u32 s14, s9, 194560
  buffer_load_dwordx4 v20, s[76:79], s14 offen offset:2048 lds
  v_mfma_f32_16x16x32_bf16 a[0:3], a[44:47], v[44:47], a[0:3]
  s_waitcnt lgkmcnt(3)
  v_mfma_f32_16x16x32_bf16 v[96:99], a[8:11], v[176:179], v[96:99]
  ds_read_b128 a[28:31], v11 offset:256
  v_mfma_f32_16x16x32_bf16 v[100:103], a[8:11], v[180:183], v[100:103]
  ds_read_b128 a[32:35], v11 offset:33024
  v_mfma_f32_16x16x32_bf16 v[104:107], a[12:15], v[176:179], v[104:107]
  buffer_load_dwordx4 v41, s[76:79], s14 offen offset:3072 lds
  v_mfma_f32_16x16x32_bf16 v[108:111], a[12:15], v[180:183], v[108:111]
  ds_read_b128 a[36:39], v15 offset:256
  s_waitcnt lgkmcnt(3)
  v_mfma_f32_16x16x32_bf16 v[112:115], a[16:19], v[176:179], v[112:115]
  v_mfma_f32_16x16x32_bf16 v[116:119], a[16:19], v[180:183], v[116:119]
  ds_read_b128 a[40:43], v15 offset:33024
  ds_read_b64_tr_b16 a[96:97], v21 offset:16384
  ds_read_b64_tr_b16 a[98:99], v21 offset:18432
  ds_read_b64_tr_b16 a[100:101], v22 offset:16384
  ds_read_b64_tr_b16 a[102:103], v22 offset:18432
  v_mfma_f32_16x16x32_bf16 v[120:123], a[20:23], v[176:179], v[120:123]
  v_mfma_f32_16x16x32_bf16 v[124:127], a[20:23], v[180:183], v[124:127]
  ds_read_b128 a[44:47], v36 offset:256
  v_mfma_f32_16x16x32_bf16 a[0:3], a[24:27], v[44:47], a[0:3]
  s_lshl_b32 s15, s3, 13
  v_add_u32 v33, s15, v16
  v_add_u32 v34, s15, v17
  ds_read_b64_tr_b16 a[104:105], v23 offset:16384
  ds_read_b64_tr_b16 a[106:107], v23 offset:18432
  ds_read_b64_tr_b16 a[108:109], v24 offset:16384
  ds_read_b64_tr_b16 a[110:111], v24 offset:18432
  v_add_u32 v35, s15, v18
  v_add_u32 v36, s15, v19
  s_barrier
  s_waitcnt lgkmcnt(11)
  v_mfma_f32_16x16x32_bf16 v[96:99], a[28:31], v[184:187], v[96:99]
  ds_read_b128 a[8:11], v16 offset:0
  v_mfma_f32_16x16x32_bf16 v[100:103], a[28:31], v[188:191], v[100:103]
  ds_read_b128 a[12:15], v16 offset:8192
  v_mfma_f32_16x16x32_bf16 v[104:107], a[32:35], v[184:187], v[104:107]
  s_add_u32 m0, s8, 12288
  s_add_u32 s14, s9, 98304
  buffer_load_dwordx4 v20, s[76:79], s14 offen offset:0 lds
  v_mfma_f32_16x16x32_bf16 v[108:111], a[32:35], v[188:191], v[108:111]
  ds_read_b128 a[16:19], v16 offset:16384
  s_waitcnt lgkmcnt(7)
  v_mfma_f32_16x16x32_bf16 v[112:115], a[36:39], v[184:187], v[112:115]
  v_mfma_f32_16x16x32_bf16 v[116:119], a[36:39], v[188:191], v[116:119]
  ds_read_b128 a[20:23], v16 offset:24576
  buffer_load_dwordx4 v41, s[76:79], s14 offen offset:1024 lds
  v_mfma_f32_16x16x32_bf16 v[120:123], a[40:43], v[184:187], v[120:123]
  v_mfma_f32_16x16x32_bf16 v[124:127], a[40:43], v[188:191], v[124:127]
  ds_read_b128 a[24:27], v33 offset:0
  v_mfma_f32_16x16x32_bf16 a[0:3], a[44:47], v[44:47], a[0:3]
  s_waitcnt lgkmcnt(3)
  v_mfma_f32_16x16x32_bf16 v[96:99], a[8:11], v[192:195], v[96:99]
  s_add_u32 s14, s9, 210944
  buffer_load_dwordx4 v20, s[76:79], s14 offen offset:2048 lds
  ds_read_b128 a[28:31], v17 offset:0
  v_mfma_f32_16x16x32_bf16 v[100:103], a[8:11], v[196:199], v[100:103]
  ds_read_b128 a[32:35], v17 offset:8192
  v_mfma_f32_16x16x32_bf16 v[104:107], a[12:15], v[192:195], v[104:107]
  v_mfma_f32_16x16x32_bf16 v[108:111], a[12:15], v[196:199], v[108:111]
  ds_read_b128 a[36:39], v17 offset:16384
  buffer_load_dwordx4 v41, s[76:79], s14 offen offset:3072 lds
  s_waitcnt lgkmcnt(3)
  v_mfma_f32_16x16x32_bf16 v[112:115], a[16:19], v[192:195], v[112:115]
  v_mfma_f32_16x16x32_bf16 v[116:119], a[16:19], v[196:199], v[116:119]
  ds_read_b128 a[40:43], v17 offset:24576
  v_mfma_f32_16x16x32_bf16 v[120:123], a[20:23], v[192:195], v[120:123]
  v_mfma_f32_16x16x32_bf16 v[124:127], a[20:23], v[196:199], v[124:127]
  s_waitcnt vmcnt(13)
  ds_read_b64_tr_b16 a[112:113], v21 offset:20480
  ds_read_b64_tr_b16 a[114:115], v21 offset:22528
  ds_read_b64_tr_b16 a[116:117], v22 offset:20480
  ds_read_b64_tr_b16 a[118:119], v22 offset:22528
  ds_read_b128 a[44:47], v34 offset:0
  v_mfma_f32_16x16x32_bf16 a[0:3], a[24:27], v[44:47], a[0:3]
  s_waitcnt lgkmcnt(7)
  v_mfma_f32_16x16x32_bf16 v[96:99], a[28:31], v[200:203], v[96:99]
  ds_read_b128 a[8:11], v18 offset:0
  v_mfma_f32_16x16x32_bf16 v[100:103], a[28:31], v[204:207], v[100:103]
  ds_read_b128 a[12:15], v18 offset:8192
  ds_read_b64_tr_b16 a[120:121], v23 offset:20480
  ds_read_b64_tr_b16 a[122:123], v23 offset:22528
  ds_read_b64_tr_b16 a[124:125], v24 offset:20480
  ds_read_b64_tr_b16 a[126:127], v24 offset:22528
  v_mfma_f32_16x16x32_bf16 v[104:107], a[32:35], v[200:203], v[104:107]
  v_mfma_f32_16x16x32_bf16 v[108:111], a[32:35], v[204:207], v[108:111]
  ds_read_b128 a[16:19], v18 offset:16384
  s_waitcnt lgkmcnt(7)
  v_mfma_f32_16x16x32_bf16 v[112:115], a[36:39], v[200:203], v[112:115]
  v_mfma_f32_16x16x32_bf16 v[116:119], a[36:39], v[204:207], v[116:119]
  s_add_u32 m0, s8, 16384
  s_add_u32 s14, s9, 229376
  buffer_load_dwordx4 v20, s[76:79], s14 offen offset:0 lds
  ds_read_b128 a[20:23], v18 offset:24576
  v_mfma_f32_16x16x32_bf16 v[120:123], a[40:43], v[200:203], v[120:123]
  v_mfma_f32_16x16x32_bf16 v[124:127], a[40:43], v[204:207], v[124:127]
  ds_read_b128 a[24:27], v35 offset:0
  v_mfma_f32_16x16x32_bf16 a[0:3], a[44:47], v[44:47], a[0:3]
  s_waitcnt lgkmcnt(7)
  v_mfma_f32_16x16x32_bf16 v[96:99], a[8:11], v[208:211], v[96:99]
  buffer_load_dwordx4 v41, s[76:79], s14 offen offset:1024 lds
  ds_read_b128 a[28:31], v19 offset:0
  v_mfma_f32_16x16x32_bf16 v[100:103], a[8:11], v[212:215], v[100:103]
  ds_read_b128 a[32:35], v19 offset:8192
  v_mfma_f32_16x16x32_bf16 v[104:107], a[12:15], v[208:211], v[104:107]
  v_mfma_f32_16x16x32_bf16 v[108:111], a[12:15], v[212:215], v[108:111]
  s_add_u32 s14, s9, 243712
  buffer_load_dwordx4 v20, s[76:79], s14 offen offset:2048 lds
  ds_read_b128 a[36:39], v19 offset:16384
  s_waitcnt lgkmcnt(3)
  v_mfma_f32_16x16x32_bf16 v[112:115], a[16:19], v[208:211], v[112:115]
  v_mfma_f32_16x16x32_bf16 v[116:119], a[16:19], v[212:215], v[116:119]
  ds_read_b128 a[40:43], v19 offset:24576
  v_mfma_f32_16x16x32_bf16 v[120:123], a[20:23], v[208:211], v[120:123]
  v_mfma_f32_16x16x32_bf16 v[124:127], a[20:23], v[212:215], v[124:127]
  buffer_load_dwordx4 v41, s[76:79], s14 offen offset:3072 lds
  ds_read_b128 a[44:47], v36 offset:0
  v_mfma_f32_16x16x32_bf16 a[0:3], a[24:27], v[44:47], a[0:3]
  s_waitcnt lgkmcnt(3)
  v_mfma_f32_16x16x32_bf16 v[96:99], a[28:31], v[216:219], v[96:99]
  ds_read_b128 a[8:11], v16 offset:256
  v_mfma_f32_16x16x32_bf16 v[100:103], a[28:31], v[220:223], v[100:103]
  s_add_u32 m0, s8, 20480
  s_add_u32 s14, s9, 262144
  buffer_load_dwordx4 v20, s[76:79], s14 offen offset:0 lds
  ds_read_b128 a[12:15], v16 offset:8448
  v_mfma_f32_16x16x32_bf16 v[104:107], a[32:35], v[216:219], v[104:107]
  v_mfma_f32_16x16x32_bf16 v[108:111], a[32:35], v[220:223], v[108:111]
  ds_read_b128 a[16:19], v16 offset:16640
  s_waitcnt lgkmcnt(3)
  v_mfma_f32_16x16x32_bf16 v[112:115], a[36:39], v[216:219], v[112:115]
  v_mfma_f32_16x16x32_bf16 v[116:119], a[36:39], v[220:223], v[116:119]
  buffer_load_dwordx4 v41, s[76:79], s14 offen offset:1024 lds
  ds_read_b128 a[20:23], v16 offset:24832
  v_mfma_f32_16x16x32_bf16 v[120:123], a[40:43], v[216:219], v[120:123]
  v_mfma_f32_16x16x32_bf16 v[124:127], a[40:43], v[220:223], v[124:127]
  ds_read_b128 a[24:27], v33 offset:256
  v_mfma_f32_16x16x32_bf16 a[0:3], a[44:47], v[44:47], a[0:3]
  s_waitcnt lgkmcnt(3)
  s_add_u32 s14, s9, 276480
  buffer_load_dwordx4 v20, s[76:79], s14 offen offset:2048 lds
  v_mfma_f32_16x16x32_bf16 v[96:99], a[8:11], v[224:227], v[96:99]
  ds_read_b128 a[28:31], v17 offset:256
  v_mfma_f32_16x16x32_bf16 v[100:103], a[8:11], v[228:231], v[100:103]
  ds_read_b128 a[32:35], v17 offset:8448
  v_mfma_f32_16x16x32_bf16 v[104:107], a[12:15], v[224:227], v[104:107]
  v_mfma_f32_16x16x32_bf16 v[108:111], a[12:15], v[228:231], v[108:111]
  buffer_load_dwordx4 v41, s[76:79], s14 offen offset:3072 lds
  ds_read_b128 a[36:39], v17 offset:16640
  s_waitcnt lgkmcnt(3)
  v_mfma_f32_16x16x32_bf16 v[112:115], a[16:19], v[224:227], v[112:115]
  v_mfma_f32_16x16x32_bf16 v[116:119], a[16:19], v[228:231], v[116:119]
  ds_read_b128 a[40:43], v17 offset:24832
  v_mfma_f32_16x16x32_bf16 v[120:123], a[20:23], v[224:227], v[120:123]
  v_mfma_f32_16x16x32_bf16 v[124:127], a[20:23], v[228:231], v[124:127]
  ds_read_b128 a[44:47], v34 offset:256
  v_mfma_f32_16x16x32_bf16 a[0:3], a[24:27], v[44:47], a[0:3]
  s_waitcnt lgkmcnt(3)
  v_mfma_f32_16x16x32_bf16 v[96:99], a[28:31], v[232:235], v[96:99]
  ds_read_b128 a[8:11], v18 offset:256
  v_mfma_f32_16x16x32_bf16 v[100:103], a[28:31], v[236:239], v[100:103]
  ds_read_b128 a[12:15], v18 offset:8448
  v_mfma_f32_16x16x32_bf16 v[104:107], a[32:35], v[232:235], v[104:107]
  v_mfma_f32_16x16x32_bf16 v[108:111], a[32:35], v[236:239], v[108:111]
  ds_read_b128 a[16:19], v18 offset:16640
  s_waitcnt lgkmcnt(3)
  v_mfma_f32_16x16x32_bf16 v[112:115], a[36:39], v[232:235], v[112:115]
  v_mfma_f32_16x16x32_bf16 v[116:119], a[36:39], v[236:239], v[116:119]
  ds_read_b128 a[20:23], v18 offset:24832
  v_mfma_f32_16x16x32_bf16 v[120:123], a[40:43], v[232:235], v[120:123]
  v_mfma_f32_16x16x32_bf16 v[124:127], a[40:43], v[236:239], v[124:127]
  ds_read_b128 a[24:27], v35 offset:256
  v_mfma_f32_16x16x32_bf16 a[0:3], a[44:47], v[44:47], a[0:3]
  s_waitcnt lgkmcnt(3)
  v_mfma_f32_16x16x32_bf16 v[96:99], a[8:11], v[240:243], v[96:99]
  ds_read_b128 a[28:31], v19 offset:256
  v_mfma_f32_16x16x32_bf16 v[100:103], a[8:11], v[244:247], v[100:103]
  ds_read_b128 a[32:35], v19 offset:8448
  v_mfma_f32_16x16x32_bf16 v[104:107], a[12:15], v[240:243], v[104:107]
  v_mfma_f32_16x16x32_bf16 v[108:111], a[12:15], v[244:247], v[108:111]
  ds_read_b128 a[36:39], v19 offset:16640
  s_waitcnt lgkmcnt(3)
  v_mfma_f32_16x16x32_bf16 v[112:115], a[16:19], v[240:243], v[112:115]
  v_mfma_f32_16x16x32_bf16 v[116:119], a[16:19], v[244:247], v[116:119]
  ds_read_b128 a[40:43], v19 offset:24832
  v_mfma_f32_16x16x32_bf16 v[120:123], a[20:23], v[240:243], v[120:123]
  v_mfma_f32_16x16x32_bf16 v[124:127], a[20:23], v[244:247], v[124:127]
  ds_read_b128 a[44:47], v36 offset:256
  v_mfma_f32_16x16x32_bf16 a[0:3], a[24:27], v[44:47], a[0:3]
  s_waitcnt lgkmcnt(0)
  v_mfma_f32_16x16x32_bf16 a[0:3], a[44:47], v[44:47], a[0:3]
  s_nop 8
  ds_write_b128 v62, a[0:3] offset:31488
  s_waitcnt lgkmcnt(0)
  s_barrier
  ds_read_b128 v[64:67], v61 offset:31488
  ds_read_b128 v[68:71], v61 offset:64256
  ds_read_b128 v[72:75], v63 offset:31488
  ds_read_b128 v[76:79], v63 offset:64256
  ds_read_b32 v30, v43 offset:31232
  ds_read_b32 v31, v43 offset:31360
  v_lshlrev_b32 v60, 5, v3
  v_add_u32 v60, s8, v60
  ds_read_b128 v[80:83], v60 offset:29952
  ds_read_b128 v[84:87], v60 offset:29968
  ds_read_b128 v[88:91], v60 offset:30080
  ds_read_b128 v[92:95], v60 offset:30096
  v_mfma_f32_16x16x32_bf16 v[96:99], a[28:31], v[248:251], v[96:99]
  v_mfma_f32_16x16x32_bf16 v[100:103], a[28:31], v[252:255], v[100:103]
  v_mfma_f32_16x16x32_bf16 v[104:107], a[32:35], v[248:251], v[104:107]
  v_mfma_f32_16x16x32_bf16 v[108:111], a[32:35], v[252:255], v[108:111]
  v_mfma_f32_16x16x32_bf16 v[112:115], a[36:39], v[248:251], v[112:115]
  v_mfma_f32_16x16x32_bf16 v[116:119], a[36:39], v[252:255], v[116:119]
  v_mfma_f32_16x16x32_bf16 v[120:123], a[40:43], v[248:251], v[120:123]
  v_mfma_f32_16x16x32_bf16 v[124:127], a[40:43], v[252:255], v[124:127]
  s_add_u32 m0, s8, 0
  s_add_u32 s14, s9, 294912
  buffer_load_dwordx4 v20, s[76:79], s14 offen offset:0 lds
  buffer_load_dwordx4 v41, s[76:79], s14 offen offset:1024 lds
  s_add_u32 s14, s9, 309248
  buffer_load_dwordx4 v20, s[76:79], s14 offen offset:2048 lds
  buffer_load_dwordx4 v41, s[76:79], s14 offen offset:3072 lds
  s_add_u32 s50, s11, 0
  buffer_load_dwordx2 v[52:53], v37, s[64:67], s50 offen sc1
  s_add_u32 m0, s8, 4096
  s_add_u32 s14, s9, 344064
  buffer_load_dwordx4 v20, s[76:79], s14 offen offset:0 lds
  s_waitcnt lgkmcnt(4)
  v_fma_f32 v96, -v56, v64, v96
  v_mul_f32 v96, v57, v96
  v_fma_f32 v97, -v56, v65, v97
  v_mul_f32 v97, v57, v97
  v_fma_f32 v98, -v56, v66, v98
  v_mul_f32 v98, v57, v98
  v_fma_f32 v99, -v56, v67, v99
  v_mul_f32 v99, v57, v99
  v_fma_f32 v100, -v58, v64, v100
  v_mul_f32 v100, v59, v100
  v_fma_f32 v101, -v58, v65, v101
  v_mul_f32 v101, v59, v101
  v_fma_f32 v102, -v58, v66, v102
  v_mul_f32 v102, v59, v102
  buffer_load_dwordx4 v41, s[76:79], s14 offen offset:1024 lds
  v_fma_f32 v103, -v58, v67, v103
  v_mul_f32 v103, v59, v103
  v_fma_f32 v104, -v56, v68, v104
  v_mul_f32 v104, v57, v104
  v_fma_f32 v105, -v56, v69, v105
  v_mul_f32 v105, v57, v105
  v_fma_f32 v106, -v56, v70, v106
  v_mul_f32 v106, v57, v106
  v_fma_f32 v107, -v56, v71, v107
  v_mul_f32 v107, v57, v107
  v_fma_f32 v108, -v58, v68, v108
  v_mul_f32 v108, v59, v108
  v_fma_f32 v109, -v58, v69, v109
  v_mul_f32 v109, v59, v109
  s_add_u32 s14, s9, 358400
  buffer_load_dwordx4 v20, s[76:79], s14 offen offset:2048 lds
  v_fma_f32 v110, -v58, v70, v110
  v_mul_f32 v110, v59, v110
  v_fma_f32 v111, -v58, v71, v111
  v_mul_f32 v111, v59, v111
  v_fma_f32 v112, -v56, v72, v112
  v_mul_f32 v112, v57, v112
  v_fma_f32 v113, -v56, v73, v113
  v_mul_f32 v113, v57, v113
  v_fma_f32 v114, -v56, v74, v114
  v_mul_f32 v114, v57, v114
  v_fma_f32 v115, -v56, v75, v115
  v_mul_f32 v115, v57, v115
  v_fma_f32 v116, -v58, v72, v116
  v_mul_f32 v116, v59, v116
  buffer_load_dwordx4 v41, s[76:79], s14 offen offset:3072 lds
  v_fma_f32 v117, -v58, v73, v117
  v_mul_f32 v117, v59, v117
  v_fma_f32 v118, -v58, v74, v118
  v_mul_f32 v118, v59, v118
  v_fma_f32 v119, -v58, v75, v119
  v_mul_f32 v119, v59, v119
  v_fma_f32 v120, -v56, v76, v120
  v_mul_f32 v120, v57, v120
  v_fma_f32 v121, -v56, v77, v121
  v_mul_f32 v121, v57, v121
  v_fma_f32 v122, -v56, v78, v122
  v_mul_f32 v122, v57, v122
  v_fma_f32 v123, -v56, v79, v123
  v_mul_f32 v123, v57, v123
  s_lshl_b32 s14, s3, 13
  s_add_u32 m0, s14, 131072
  s_add_u32 s14, s9, 376832
  buffer_load_dwordx4 v20, s[76:79], s14 offen offset:0 lds
  v_fma_f32 v124, -v58, v76, v124
  v_mul_f32 v124, v59, v124
  v_fma_f32 v125, -v58, v77, v125
  v_mul_f32 v125, v59, v125
  v_fma_f32 v126, -v58, v78, v126
  v_mul_f32 v126, v59, v126
  v_fma_f32 v127, -v58, v79, v127
  v_mul_f32 v127, v59, v127
  ds_read_b128 v[64:67], v60 offset:29696
  ds_read_b128 v[68:71], v60 offset:29712
  ds_read_b128 v[72:75], v60 offset:29824
  ds_read_b128 v[76:79], v60 offset:29840
  s_waitcnt lgkmcnt(4)
  v_mul_f32 v4, v96, v88
  buffer_load_dwordx4 v41, s[76:79], s14 offen offset:1024 lds
  v_mul_f32 v96, v96, v80
  v_fma_f32 v96, -v112, v88, v96
  v_fma_f32 v112, v112, v80, v4
  v_mul_f32 v5, v97, v89
  v_mul_f32 v97, v97, v81
  v_fma_f32 v97, -v113, v89, v97
  v_fma_f32 v113, v113, v81, v5
  v_mul_f32 v6, v98, v90
  v_mul_f32 v98, v98, v82
  v_fma_f32 v98, -v114, v90, v98
  v_fma_f32 v114, v114, v82, v6
  v_mul_f32 v7, v99, v91
  v_mul_f32 v99, v99, v83
  v_fma_f32 v99, -v115, v91, v99
  s_add_u32 s14, s9, 391168
  buffer_load_dwordx4 v20, s[76:79], s14 offen offset:2048 lds
  v_fma_f32 v115, v115, v83, v7
  v_mul_f32 v4, v104, v92
  v_mul_f32 v104, v104, v84
  v_fma_f32 v104, -v120, v92, v104
  v_fma_f32 v120, v120, v84, v4
  v_mul_f32 v5, v105, v93
  v_mul_f32 v105, v105, v85
  v_fma_f32 v105, -v121, v93, v105
  v_fma_f32 v121, v121, v85, v5
  v_mul_f32 v6, v106, v94
  v_mul_f32 v106, v106, v86
  v_fma_f32 v106, -v122, v94, v106
  v_fma_f32 v122, v122, v86, v6
  v_mul_f32 v7, v107, v95
  buffer_load_dwordx4 v41, s[76:79], s14 offen offset:3072 lds
  v_mul_f32 v107, v107, v87
  v_fma_f32 v107, -v123, v95, v107
  v_fma_f32 v123, v123, v87, v7
  v_mul_f32 v4, v100, v88
  v_mul_f32 v100, v100, v80
  v_fma_f32 v100, -v116, v88, v100
  v_fma_f32 v116, v116, v80, v4
  v_mul_f32 v5, v101, v89
  v_mul_f32 v101, v101, v81
  v_fma_f32 v101, -v117, v89, v101
  v_fma_f32 v117, v117, v81, v5
  v_mul_f32 v6, v102, v90
  v_mul_f32 v102, v102, v82
  v_fma_f32 v102, -v118, v90, v102
  s_lshl_b32 s14, s3, 13
  s_add_u32 m0, s14, 135168
  s_add_u32 s14, s9, 409600
  buffer_load_dwordx4 v20, s[76:79], s14 offen offset:0 lds
  v_fma_f32 v118, v118, v82, v6
  v_mul_f32 v7, v103, v91
  v_mul_f32 v103, v103, v83
  v_fma_f32 v103, -v119, v91, v103
  v_fma_f32 v119, v119, v83, v7
  v_mul_f32 v4, v108, v92
  v_mul_f32 v108, v108, v84
  v_fma_f32 v108, -v124, v92, v108
  v_fma_f32 v124, v124, v84, v4
  v_mul_f32 v5, v109, v93
  v_mul_f32 v109, v109, v85
  v_fma_f32 v109, -v125, v93, v109
  v_fma_f32 v125, v125, v85, v5
  v_mul_f32 v6, v110, v94
  buffer_load_dwordx4 v41, s[76:79], s14 offen offset:1024 lds
  v_mul_f32 v110, v110, v86
  v_fma_f32 v110, -v126, v94, v110
  v_fma_f32 v126, v126, v86, v6
  v_mul_f32 v7, v111, v95
  v_mul_f32 v111, v111, v87
  v_fma_f32 v111, -v127, v95, v111
  v_fma_f32 v127, v127, v87, v7
  ds_read_b128 v[80:83], v60 offset:30208
  ds_read_b128 v[84:87], v60 offset:30224
  ds_read_b128 v[88:91], v60 offset:30336
  ds_read_b128 v[92:95], v60 offset:30352
  s_waitcnt lgkmcnt(4)
  v_fma_f32 v100, v96, v64, v100
  v_fma_f32 v116, v96, v72, v116
  v_fma_f32 v100, -v112, v72, v100
  s_add_u32 s14, s9, 423936
  buffer_load_dwordx4 v20, s[76:79], s14 offen offset:2048 lds
  v_fma_f32 v116, v112, v64, v116
  v_fma_f32 v101, v97, v65, v101
  v_fma_f32 v117, v97, v73, v117
  v_fma_f32 v101, -v113, v73, v101
  v_fma_f32 v117, v113, v65, v117
  v_fma_f32 v102, v98, v66, v102
  v_fma_f32 v118, v98, v74, v118
  v_fma_f32 v102, -v114, v74, v102
  v_fma_f32 v118, v114, v66, v118
  v_fma_f32 v103, v99, v67, v103
  v_fma_f32 v119, v99, v75, v119
  v_fma_f32 v103, -v115, v75, v103
  v_fma_f32 v119, v115, v67, v119
  v_fma_f32 v108, v104, v68, v108
  buffer_load_dwordx4 v41, s[76:79], s14 offen offset:3072 lds
  v_fma_f32 v124, v104, v76, v124
  v_fma_f32 v108, -v120, v76, v108
  v_fma_f32 v124, v120, v68, v124
  v_fma_f32 v109, v105, v69, v109
  v_fma_f32 v125, v105, v77, v125
  v_fma_f32 v109, -v121, v77, v109
  v_fma_f32 v125, v121, v69, v125
  v_fma_f32 v110, v106, v70, v110
  v_fma_f32 v126, v106, v78, v126
  v_fma_f32 v110, -v122, v78, v110
  v_fma_f32 v126, v122, v70, v126
  v_fma_f32 v111, v107, v71, v111
  v_fma_f32 v127, v107, v79, v127
  v_fma_f32 v111, -v123, v79, v111
  v_fma_f32 v127, v123, v71, v127
  v_mul_f32 v4, 0x42000000, v30
  v_mul_f32 v34, 0x42000000, v31
  v_exp_f32 v4, v4
  v_fract_f32 v34, v34
  v_cos_f32 v33, v34
  v_sin_f32 v34, v34
  v_mul_f32 v33, v4, v33
  v_mul_f32 v34, v4, v34
  v_mul_f32 v5, 0x43000000, v30
  v_mul_f32 v36, 0x43000000, v31
  v_exp_f32 v5, v5
  v_fract_f32 v36, v36
  v_cos_f32 v35, v36
  v_sin_f32 v36, v36
  v_mul_f32 v35, v5, v35
  v_mul_f32 v36, v5, v36
  v_mul_f32 v6, 0x43800000, v30
  v_mul_f32 v38, 0x43800000, v31
  v_exp_f32 v6, v6
  v_fract_f32 v38, v38
  v_cos_f32 v18, v38
  v_sin_f32 v38, v38
  v_mul_f32 v18, v6, v18
  v_mul_f32 v38, v6, v38
  s_lshl_b32 s15, s3, 5
  v_cvt_f32_u32 v7, s15
  v_mul_f32 v4, v7, v30
  v_mul_f32 v40, v7, v31
  v_exp_f32 v4, v4
  v_fract_f32 v40, v40
  v_cos_f32 v39, v40
  v_sin_f32 v40, v40
  v_mul_f32 v39, v4, v39
  v_mul_f32 v40, v4, v40
  s_waitcnt vmcnt(12)
  s_mov_b32 s51, 0
Lpa:
  v_cmp_ne_u64 vcc, v[52:53], v[54:55]
  s_nop 0
  s_cmp_eq_u64 vcc, 0
  s_cbranch_scc1 Lpaok
  buffer_load_dwordx2 v[52:53], v37, s[64:67], s50 offen sc1
  s_add_u32 s51, s51, 1
  s_waitcnt vmcnt(0)
  s_cmp_lt_u32 s51, 0x40000
  s_cbranch_scc1 Lpa
Lpaok:
  s_add_u32 s14, s96, 4096
  buffer_load_dwordx4 v[128:131], v25, s[64:67], s14 offen sc1
  ds_read_b128 v[64:67], v60 offset:30464
  ds_read_b128 v[68:71], v60 offset:30480
  ds_read_b128 v[72:75], v60 offset:30592
  ds_read_b128 v[76:79], v60 offset:30608
  s_waitcnt lgkmcnt(4)
  v_mov_b32_dpp v4, v100 row_shr:1 row_mask:0xf bank_mask:0xf bound_ctrl:0
  v_mov_b32_dpp v8, v116 row_shr:1 row_mask:0xf bank_mask:0xf bound_ctrl:0
  v_mov_b32_dpp v5, v101 row_shr:1 row_mask:0xf bank_mask:0xf bound_ctrl:0
  v_mov_b32_dpp v9, v117 row_shr:1 row_mask:0xf bank_mask:0xf bound_ctrl:0
  v_mov_b32_dpp v6, v102 row_shr:1 row_mask:0xf bank_mask:0xf bound_ctrl:0
  v_mov_b32_dpp v10, v118 row_shr:1 row_mask:0xf bank_mask:0xf bound_ctrl:0
  buffer_load_dwordx4 v[132:135], v26, s[64:67], s14 offen sc1
  v_mov_b32_dpp v7, v103 row_shr:1 row_mask:0xf bank_mask:0xf bound_ctrl:0
  v_mov_b32_dpp v11, v119 row_shr:1 row_mask:0xf bank_mask:0xf bound_ctrl:0
  v_fma_f32 v100, v4, v80, v100
  v_fma_f32 v116, v4, v88, v116
  v_fma_f32 v100, -v8, v88, v100
  v_fma_f32 v116, v8, v80, v116
  v_fma_f32 v101, v5, v81, v101
  v_fma_f32 v117, v5, v89, v117
  v_fma_f32 v101, -v9, v89, v101
  v_fma_f32 v117, v9, v81, v117
  s_add_u32 s14, s97, 4096
  buffer_load_dwordx4 v[136:139], v25, s[64:67], s14 offen sc1
  v_fma_f32 v102, v6, v82, v102
  v_fma_f32 v118, v6, v90, v118
  v_fma_f32 v102, -v10, v90, v102
  v_fma_f32 v118, v10, v82, v118
  v_fma_f32 v103, v7, v83, v103
  v_fma_f32 v119, v7, v91, v119
  v_fma_f32 v103, -v11, v91, v103
  v_fma_f32 v119, v11, v83, v119
  v_mov_b32_dpp v4, v108 row_shr:1 row_mask:0xf bank_mask:0xf bound_ctrl:0
  v_mov_b32_dpp v8, v124 row_shr:1 row_mask:0xf bank_mask:0xf bound_ctrl:0
  buffer_load_dwordx4 v[140:143], v26, s[64:67], s14 offen sc1
  v_mov_b32_dpp v5, v109 row_shr:1 row_mask:0xf bank_mask:0xf bound_ctrl:0
  v_mov_b32_dpp v9, v125 row_shr:1 row_mask:0xf bank_mask:0xf bound_ctrl:0
  v_mov_b32_dpp v6, v110 row_shr:1 row_mask:0xf bank_mask:0xf bound_ctrl:0
  v_mov_b32_dpp v10, v126 row_shr:1 row_mask:0xf bank_mask:0xf bound_ctrl:0
  v_mov_b32_dpp v7, v111 row_shr:1 row_mask:0xf bank_mask:0xf bound_ctrl:0
  v_mov_b32_dpp v11, v127 row_shr:1 row_mask:0xf bank_mask:0xf bound_ctrl:0
  v_fma_f32 v108, v4, v84, v108
  v_fma_f32 v124, v4, v92, v124
  v_fma_f32 v108, -v8, v92, v108
  v_fma_f32 v124, v8, v84, v124
  s_add_u32 s14, s96, 6144
  buffer_load_dwordx4 v[144:147], v25, s[64:67], s14 offen sc1
  v_fma_f32 v109, v5, v85, v109
  v_fma_f32 v125, v5, v93, v125
  v_fma_f32 v109, -v9, v93, v109
  v_fma_f32 v125, v9, v85, v125
  v_fma_f32 v110, v6, v86, v110
  v_fma_f32 v126, v6, v94, v126
  v_fma_f32 v110, -v10, v94, v110
  v_fma_f32 v126, v10, v86, v126
  v_fma_f32 v111, v7, v87, v111
  v_fma_f32 v127, v7, v95, v127
  buffer_load_dwordx4 v[148:151], v26, s[64:67], s14 offen sc1
  v_fma_f32 v111, -v11, v95, v111
  v_fma_f32 v127, v11, v87, v127
  ds_read_b128 v[80:83], v60 offset:30720
  ds_read_b128 v[84:87], v60 offset:30736
  ds_read_b128 v[88:91], v60 offset:30848
  ds_read_b128 v[92:95], v60 offset:30864
  s_waitcnt lgkmcnt(4)
  v_mov_b32_dpp v4, v100 row_shr:2 row_mask:0xf bank_mask:0xf bound_ctrl:0
  v_mov_b32_dpp v8, v116 row_shr:2 row_mask:0xf bank_mask:0xf bound_ctrl:0
  v_mov_b32_dpp v5, v101 row_shr:2 row_mask:0xf bank_mask:0xf bound_ctrl:0
  s_add_u32 s14, s97, 6144
  buffer_load_dwordx4 v[152:155], v25, s[64:67], s14 offen sc1
  v_mov_b32_dpp v9, v117 row_shr:2 row_mask:0xf bank_mask:0xf bound_ctrl:0
  v_mov_b32_dpp v6, v102 row_shr:2 row_mask:0xf bank_mask:0xf bound_ctrl:0
  v_mov_b32_dpp v10, v118 row_shr:2 row_mask:0xf bank_mask:0xf bound_ctrl:0
  v_mov_b32_dpp v7, v103 row_shr:2 row_mask:0xf bank_mask:0xf bound_ctrl:0
  v_mov_b32_dpp v11, v119 row_shr:2 row_mask:0xf bank_mask:0xf bound_ctrl:0
  v_fma_f32 v100, v4, v64, v100
  v_fma_f32 v116, v4, v72, v116
  v_fma_f32 v100, -v8, v72, v100
  v_fma_f32 v116, v8, v64, v116
  v_fma_f32 v101, v5, v65, v101
  buffer_load_dwordx4 v[156:159], v26, s[64:67], s14 offen sc1
  v_fma_f32 v117, v5, v73, v117
  v_fma_f32 v101, -v9, v73, v101
  v_fma_f32 v117, v9, v65, v117
  v_fma_f32 v102, v6, v66, v102
  v_fma_f32 v118, v6, v74, v118
  v_fma_f32 v102, -v10, v74, v102
  v_fma_f32 v118, v10, v66, v118
  v_fma_f32 v103, v7, v67, v103
  v_fma_f32 v119, v7, v75, v119
  v_fma_f32 v103, -v11, v75, v103
  s_add_u32 s14, s96, 8192
  buffer_load_dwordx4 v[160:163], v25, s[64:67], s14 offen sc1
  v_fma_f32 v119, v11, v67, v119
  v_mov_b32_dpp v4, v108 row_shr:2 row_mask:0xf bank_mask:0xf bound_ctrl:0
  v_mov_b32_dpp v8, v124 row_shr:2 row_mask:0xf bank_mask:0xf bound_ctrl:0
  v_mov_b32_dpp v5, v109 row_shr:2 row_mask:0xf bank_mask:0xf bound_ctrl:0
  v_mov_b32_dpp v9, v125 row_shr:2 row_mask:0xf bank_mask:0xf bound_ctrl:0
  v_mov_b32_dpp v6, v110 row_shr:2 row_mask:0xf bank_mask:0xf bound_ctrl:0
  v_mov_b32_dpp v10, v126 row_shr:2 row_mask:0xf bank_mask:0xf bound_ctrl:0
  v_mov_b32_dpp v7, v111 row_shr:2 row_mask:0xf bank_mask:0xf bound_ctrl:0
  v_mov_b32_dpp v11, v127 row_shr:2 row_mask:0xf bank_mask:0xf bound_ctrl:0
  v_fma_f32 v108, v4, v68, v108
  buffer_load_dwordx4 v[164:167], v26, s[64:67], s14 offen sc1
  v_fma_f32 v124, v4, v76, v124
  v_fma_f32 v108, -v8, v76, v108
  v_fma_f32 v124, v8, v68, v124
  v_fma_f32 v109, v5, v69, v109
  v_fma_f32 v125, v5, v77, v125
  v_fma_f32 v109, -v9, v77, v109
  v_fma_f32 v125, v9, v69, v125
  v_fma_f32 v110, v6, v70, v110
  v_fma_f32 v126, v6, v78, v126
  v_fma_f32 v110, -v10, v78, v110
  s_add_u32 s14, s97, 8192
  buffer_load_dwordx4 v[168:171], v25, s[64:67], s14 offen sc1
  v_fma_f32 v126, v10, v70, v126
  v_fma_f32 v111, v7, v71, v111
  v_fma_f32 v127, v7, v79, v127
  v_fma_f32 v111, -v11, v79, v111
  v_fma_f32 v127, v11, v71, v127
  ds_read_b128 v[64:67], v60 offset:30976
  ds_read_b128 v[68:71], v60 offset:30992
  ds_read_b128 v[72:75], v60 offset:31104
  ds_read_b128 v[76:79], v60 offset:31120
  s_waitcnt lgkmcnt(4)
  v_mov_b32_dpp v4, v100 row_shr:4 row_mask:0xf bank_mask:0xf bound_ctrl:0
  buffer_load_dwordx4 v[172:175], v26, s[64:67], s14 offen sc1
  v_mov_b32_dpp v8, v116 row_shr:4 row_mask:0xf bank_mask:0xf bound_ctrl:0
  v_mov_b32_dpp v5, v101 row_shr:4 row_mask:0xf bank_mask:0xf bound_ctrl:0
  v_mov_b32_dpp v9, v117 row_shr:4 row_mask:0xf bank_mask:0xf bound_ctrl:0
  v_mov_b32_dpp v6, v102 row_shr:4 row_mask:0xf bank_mask:0xf bound_ctrl:0
  v_mov_b32_dpp v10, v118 row_shr:4 row_mask:0xf bank_mask:0xf bound_ctrl:0
  v_mov_b32_dpp v7, v103 row_shr:4 row_mask:0xf bank_mask:0xf bound_ctrl:0
  v_mov_b32_dpp v11, v119 row_shr:4 row_mask:0xf bank_mask:0xf bound_ctrl:0
  v_fma_f32 v100, v4, v80, v100
  v_fma_f32 v116, v4, v88, v116
  v_fma_f32 v100, -v8, v88, v100
  s_add_u32 s14, s96, 15616
  buffer_load_dwordx4 v[176:179], v25, s[64:67], s14 offen sc1
  v_fma_f32 v116, v8, v80, v116
  v_fma_f32 v101, v5, v81, v101
  v_fma_f32 v117, v5, v89, v117
  v_fma_f32 v101, -v9, v89, v101
  v_fma_f32 v117, v9, v81, v117
  v_fma_f32 v102, v6, v82, v102
  v_fma_f32 v118, v6, v90, v118
  v_fma_f32 v102, -v10, v90, v102
  v_fma_f32 v118, v10, v82, v118
  v_fma_f32 v103, v7, v83, v103
  buffer_load_dwordx4 v[180:183], v26, s[64:67], s14 offen sc1
  v_fma_f32 v119, v7, v91, v119
  v_fma_f32 v103, -v11, v91, v103
  v_fma_f32 v119, v11, v83, v119
  v_mov_b32_dpp v4, v108 row_shr:4 row_mask:0xf bank_mask:0xf bound_ctrl:0
  v_mov_b32_dpp v8, v124 row_shr:4 row_mask:0xf bank_mask:0xf bound_ctrl:0
  v_mov_b32_dpp v5, v109 row_shr:4 row_mask:0xf bank_mask:0xf bound_ctrl:0
  v_mov_b32_dpp v9, v125 row_shr:4 row_mask:0xf bank_mask:0xf bound_ctrl:0
  v_mov_b32_dpp v6, v110 row_shr:4 row_mask:0xf bank_mask:0xf bound_ctrl:0
  v_mov_b32_dpp v10, v126 row_shr:4 row_mask:0xf bank_mask:0xf bound_ctrl:0
  v_mov_b32_dpp v7, v111 row_shr:4 row_mask:0xf bank_mask:0xf bound_ctrl:0
  s_add_u32 s14, s97, 15616
  buffer_load_dwordx4 v[184:187], v25, s[64:67], s14 offen sc1
  v_mov_b32_dpp v11, v127 row_shr:4 row_mask:0xf bank_mask:0xf bound_ctrl:0
  v_fma_f32 v108, v4, v84, v108
  v_fma_f32 v124, v4, v92, v124
  v_fma_f32 v108, -v8, v92, v108
  v_fma_f32 v124, v8, v84, v124
  v_fma_f32 v109, v5, v85, v109
  v_fma_f32 v125, v5, v93, v125
  v_fma_f32 v109, -v9, v93, v109
  v_fma_f32 v125, v9, v85, v125
  v_fma_f32 v110, v6, v86, v110
  buffer_load_dwordx4 v[188:191], v26, s[64:67], s14 offen sc1
  v_fma_f32 v126, v6, v94, v126
  v_fma_f32 v110, -v10, v94, v110
  v_fma_f32 v126, v10, v86, v126
  v_fma_f32 v111, v7, v87, v111
  v_fma_f32 v127, v7, v95, v127
  v_fma_f32 v111, -v11, v95, v111
  v_fma_f32 v127, v11, v87, v127
  ds_read_b128 v[80:83], v60 offset:31232
  ds_read_b128 v[84:87], v60 offset:31248
  ds_read_b128 v[88:91], v60 offset:31360
  s_add_u32 s14, s96, 17664
  buffer_load_dwordx4 v[192:195], v25, s[64:67], s14 offen sc1
  ds_read_b128 v[92:95], v60 offset:31376
  s_waitcnt lgkmcnt(4)
  v_mov_b32_dpp v4, v100 row_shr:8 row_mask:0xf bank_mask:0xf bound_ctrl:0
  v_mov_b32_dpp v8, v116 row_shr:8 row_mask:0xf bank_mask:0xf bound_ctrl:0
  v_mov_b32_dpp v5, v101 row_shr:8 row_mask:0xf bank_mask:0xf bound_ctrl:0
  v_mov_b32_dpp v9, v117 row_shr:8 row_mask:0xf bank_mask:0xf bound_ctrl:0
  v_mov_b32_dpp v6, v102 row_shr:8 row_mask:0xf bank_mask:0xf bound_ctrl:0
  v_mov_b32_dpp v10, v118 row_shr:8 row_mask:0xf bank_mask:0xf bound_ctrl:0
  v_mov_b32_dpp v7, v103 row_shr:8 row_mask:0xf bank_mask:0xf bound_ctrl:0
  v_mov_b32_dpp v11, v119 row_shr:8 row_mask:0xf bank_mask:0xf bound_ctrl:0
  buffer_load_dwordx4 v[196:199], v26, s[64:67], s14 offen sc1
  v_fma_f32 v100, v4, v64, v100
  v_fma_f32 v116, v4, v72, v116
  v_fma_f32 v100, -v8, v72, v100
  v_fma_f32 v116, v8, v64, v116
  v_fma_f32 v101, v5, v65, v101
  v_fma_f32 v117, v5, v73, v117
  v_fma_f32 v101, -v9, v73, v101
  v_fma_f32 v117, v9, v65, v117
  v_fma_f32 v102, v6, v66, v102
  v_fma_f32 v118, v6, v74, v118
  s_add_u32 s14, s97, 17664
  buffer_load_dwordx4 v[200:203], v25, s[64:67], s14 offen sc1
  v_fma_f32 v102, -v10, v74, v102
  v_fma_f32 v118, v10, v66, v118
  v_fma_f32 v103, v7, v67, v103
  v_fma_f32 v119, v7, v75, v119
  v_fma_f32 v103, -v11, v75, v103
  v_fma_f32 v119, v11, v67, v119
  v_mov_b32_dpp v4, v108 row_shr:8 row_mask:0xf bank_mask:0xf bound_ctrl:0
  v_mov_b32_dpp v8, v124 row_shr:8 row_mask:0xf bank_mask:0xf bound_ctrl:0
  v_mov_b32_dpp v5, v109 row_shr:8 row_mask:0xf bank_mask:0xf bound_ctrl:0
  v_mov_b32_dpp v9, v125 row_shr:8 row_mask:0xf bank_mask:0xf bound_ctrl:0
  buffer_load_dwordx4 v[204:207], v26, s[64:67], s14 offen sc1
  v_mov_b32_dpp v6, v110 row_shr:8 row_mask:0xf bank_mask:0xf bound_ctrl:0
  v_mov_b32_dpp v10, v126 row_shr:8 row_mask:0xf bank_mask:0xf bound_ctrl:0
  v_mov_b32_dpp v7, v111 row_shr:8 row_mask:0xf bank_mask:0xf bound_ctrl:0
  v_mov_b32_dpp v11, v127 row_shr:8 row_mask:0xf bank_mask:0xf bound_ctrl:0
  v_fma_f32 v108, v4, v68, v108
  v_fma_f32 v124, v4, v76, v124
  v_fma_f32 v108, -v8, v76, v108
  v_fma_f32 v124, v8, v68, v124
  v_fma_f32 v109, v5, v69, v109
  v_fma_f32 v125, v5, v77, v125
  s_add_u32 s14, s96, 19712
  buffer_load_dwordx4 v[208:211], v25, s[64:67], s14 offen sc1
  v_fma_f32 v109, -v9, v77, v109
  v_fma_f32 v125, v9, v69, v125
  v_fma_f32 v110, v6, v70, v110
  v_fma_f32 v126, v6, v78, v126
  v_fma_f32 v110, -v10, v78, v110
  v_fma_f32 v126, v10, v70, v126
  v_fma_f32 v111, v7, v71, v111
  v_fma_f32 v127, v7, v79, v127
  v_fma_f32 v111, -v11, v79, v111
  v_fma_f32 v127, v11, v71, v127
  buffer_load_dwordx4 v[212:215], v26, s[64:67], s14 offen sc1
  s_add_u32 s14, s97, 19712
  buffer_load_dwordx4 v[216:219], v25, s[64:67], s14 offen sc1
  buffer_load_dwordx4 v[220:223], v26, s[64:67], s14 offen sc1
  v_cmp_eq_u32 vcc, 15, v2
  s_nop 0
  s_and_saveexec_b64 s[92:93], vcc
  ds_write_b128 v60, v[100:103] offset:31744
  ds_write_b128 v60, v[108:111] offset:31760
  ds_write_b128 v60, v[116:119] offset:31872
  ds_write_b128 v60, v[124:127] offset:31888
  s_mov_b64 exec, s[92:93]
  s_waitcnt lgkmcnt(0)
  s_barrier
  v_and_b32 v61, 31, v1
  v_lshlrev_b32 v61, 2, v61
  v_add_u32 v63, 0x10000, v61
  ds_read_b32 v4, v61 offset:31744
  ds_read_b32 v5, v61 offset:31872
  ds_read_b32 v6, v61 offset:64512
  ds_read_b32 v7, v61 offset:64640
  ds_read_b32 v8, v63 offset:31744
  ds_read_b32 v9, v63 offset:31872
  ds_read_b32 v10, v63 offset:64512
  ds_read_b32 v11, v63 offset:64640
  s_add_u32 s14, s96, 10240
  buffer_load_dwordx2 v[224:225], v27, s[64:67], s14 offen sc1
  buffer_load_dwordx2 v[228:229], v28, s[64:67], s14 offen sc1
  s_add_u32 s14, s96, 21760
  buffer_load_dwordx2 v[226:227], v27, s[64:67], s14 offen sc1
  buffer_load_dwordx2 v[230:231], v28, s[64:67], s14 offen sc1
  s_waitcnt lgkmcnt(0)
  v_mov_b32 v16, 0
  v_mov_b32 v17, 0
  s_cmp_le_u32 s3, 0
  s_cbranch_scc1 LT
  v_fma_f32 v4, v16, v33, v4
  v_fma_f32 v5, v16, v34, v5
  v_fma_f32 v4, -v17, v34, v4
  v_fma_f32 v5, v17, v33, v5
  v_mov_b32 v16, v4
  v_mov_b32 v17, v5
  s_cmp_le_u32 s3, 1
  s_cbranch_scc1 LT
  v_fma_f32 v6, v16, v33, v6
  v_fma_f32 v7, v16, v34, v7
  v_fma_f32 v6, -v17, v34, v6
  v_fma_f32 v7, v17, v33, v7
  v_mov_b32 v16, v6
  v_mov_b32 v17, v7
  s_cmp_le_u32 s3, 2
  s_cbranch_scc1 LT
  v_fma_f32 v8, v16, v33, v8
  v_fma_f32 v9, v16, v34, v9
  v_fma_f32 v8, -v17, v34, v8
  v_fma_f32 v9, v17, v33, v9
  v_mov_b32 v16, v8
  v_mov_b32 v17, v9
  v_fma_f32 v12, v16, v33, v10
  v_fma_f32 v13, v16, v34, v11
  v_fma_f32 v12, -v17, v34, v12
  v_fma_f32 v13, v17, v33, v13
  v_mov_b32 v14, s88
  v_mov_b32 v15, s89
  s_lshl_b32 s15, s5, 4
  s_add_u32 s15, s15, s4
  s_lshl_b32 s15, s15, 9
  s_add_u32 s15, s15, 16777216
  v_lshlrev_b32 v63, 2, v61
  buffer_store_dwordx4 v[12:15], v63, s[64:67], s15 offen sc1
LT:
  s_add_u32 s14, s97, 10240
  buffer_load_dwordx2 v[232:233], v27, s[64:67], s14 offen sc1
  buffer_load_dwordx2 v[236:237], v28, s[64:67], s14 offen sc1
  v_lshrrev_b32 v61, 5, v1
  v_sub_u32 v61, s4, v61
  v_and_b32 v62, 31, v1
  v_lshlrev_b32 v62, 4, v62
  s_lshl_b32 s13, s5, 13
  s_add_u32 s14, s97, 21760
  buffer_load_dwordx2 v[234:235], v27, s[64:67], s14 offen sc1
  buffer_load_dwordx2 v[238:239], v28, s[64:67], s14 offen sc1
  s_add_u32 s13, s13, 16777216
  v_mov_b32 v19, 0x7f000000
  v_add_u32 v63, -1, v61
  v_cmp_le_i32 vcc, 0, v63
  v_lshl_add_u32 v63, v63, 9, v62
  s_add_u32 s14, s96, 27136
  buffer_load_dwordx4 v[240:243], v25, s[64:67], s14 offen sc1
  v_cndmask_b32 v4, v19, v63, vcc
  v_add_u32 v63, -3, v61
  v_cmp_le_i32 vcc, 0, v63
  v_lshl_add_u32 v63, v63, 9, v62
  s_nop 0
  v_cndmask_b32 v5, v19, v63, vcc
  buffer_load_dwordx4 v[244:247], v26, s[64:67], s14 offen sc1
  v_add_u32 v63, -5, v61
  v_cmp_le_i32 vcc, 0, v63
  v_lshl_add_u32 v63, v63, 9, v62
  s_nop 0
  v_cndmask_b32 v6, v19, v63, vcc
  v_add_u32 v63, -7, v61
  s_add_u32 s14, s97, 27136
  buffer_load_dwordx4 v[248:251], v25, s[64:67], s14 offen sc1
  v_cmp_le_i32 vcc, 0, v63
  v_lshl_add_u32 v63, v63, 9, v62
  s_nop 0
  v_cndmask_b32 v7, v19, v63, vcc
  v_add_u32 v63, -9, v61
  v_cmp_le_i32 vcc, 0, v63
  buffer_load_dwordx4 v[252:255], v26, s[64:67], s14 offen sc1
  v_lshl_add_u32 v63, v63, 9, v62
  v_cndmask_b32 v8, v19, v63, vcc
  v_add_u32 v63, -11, v61
  v_cmp_le_i32 vcc, 0, v63
  v_lshl_add_u32 v63, v63, 9, v62
  s_nop 0
  v_cndmask_b32 v9, v19, v63, vcc
  v_add_u32 v63, -13, v61
  v_cmp_le_i32 vcc, 0, v63
  v_lshl_add_u32 v63, v63, 9, v62
  s_nop 0
  v_cndmask_b32 v10, v19, v63, vcc
  v_add_u32 v63, -15, v61
  v_cmp_le_i32 vcc, 0, v63
  v_lshl_add_u32 v63, v63, 9, v62
  s_nop 0
  v_cndmask_b32 v11, v19, v63, vcc
  s_waitcnt vmcnt(32)
  v_mfma_f32_16x16x32_bf16 a[0:3], a[64:67], v[128:131], 0
  v_lshl_add_u32 v0, v2, 1, 2
  v_cvt_f32_u32 v0, v0
  v_mfma_f32_16x16x32_bf16 a[16:19], a[64:67], v[132:135], 0
  v_mul_f32 v52, v0, v80
  v_mul_f32 v53, v0, v81
  v_mfma_f32_16x16x32_bf16 a[32:35], a[64:67], v[136:139], 0
  v_mul_f32 v72, v0, v88
  v_mul_f32 v73, v0, v89
  v_mfma_f32_16x16x32_bf16 a[48:51], a[64:67], v[140:143], 0
  v_exp_f32 v52, v52
  v_exp_f32 v53, v53
  ds_read_b64_tr_b16 a[64:65], v21 offset:24576
  ds_read_b64_tr_b16 a[66:67], v21 offset:26624
  v_fract_f32 v72, v72
  v_fract_f32 v73, v73
  v_mfma_f32_16x16x32_bf16 a[4:7], a[68:71], v[128:131], 0
  v_cos_f32 v64, v72
  v_cos_f32 v65, v73
  v_mfma_f32_16x16x32_bf16 a[20:23], a[68:71], v[132:135], 0
  v_sin_f32 v72, v72
  v_sin_f32 v73, v73
  v_mfma_f32_16x16x32_bf16 a[36:39], a[68:71], v[136:139], 0
  v_mul_f32 v64, v52, v64
  v_mul_f32 v65, v53, v65
  v_mfma_f32_16x16x32_bf16 a[52:55], a[68:71], v[140:143], 0
  v_mul_f32 v72, v52, v72
  v_mul_f32 v73, v53, v73
  ds_read_b64_tr_b16 a[68:69], v22 offset:24576
  ds_read_b64_tr_b16 a[70:71], v22 offset:26624
  v_mfma_f32_16x16x32_bf16 a[8:11], a[72:75], v[128:131], 0
  v_mul_f32 v52, v0, v82
  v_mul_f32 v53, v0, v83
  v_mfma_f32_16x16x32_bf16 a[24:27], a[72:75], v[132:135], 0
  v_mul_f32 v74, v0, v90
  v_mul_f32 v75, v0, v91
  v_mfma_f32_16x16x32_bf16 a[40:43], a[72:75], v[136:139], 0
  v_exp_f32 v52, v52
  v_exp_f32 v53, v53
  v_mfma_f32_16x16x32_bf16 a[56:59], a[72:75], v[140:143], 0
  v_fract_f32 v74, v74
  v_fract_f32 v75, v75
  ds_read_b64_tr_b16 a[72:73], v23 offset:24576
  ds_read_b64_tr_b16 a[74:75], v23 offset:26624
  v_cos_f32 v66, v74
  v_cos_f32 v67, v75
  v_mfma_f32_16x16x32_bf16 a[12:15], a[76:79], v[128:131], 0
  v_sin_f32 v74, v74
  v_sin_f32 v75, v75
  v_mfma_f32_16x16x32_bf16 a[28:31], a[76:79], v[132:135], 0
  v_mul_f32 v66, v52, v66
  v_mul_f32 v67, v53, v67
  v_mfma_f32_16x16x32_bf16 a[44:47], a[76:79], v[136:139], 0
  v_mul_f32 v74, v52, v74
  v_mul_f32 v75, v53, v75
  v_mfma_f32_16x16x32_bf16 a[60:63], a[76:79], v[140:143], 0
  ds_read_b64_tr_b16 a[76:77], v24 offset:24576
  ds_read_b64_tr_b16 a[78:79], v24 offset:26624
  s_waitcnt vmcnt(28)
  v_mfma_f32_16x16x32_bf16 a[0:3], a[80:83], v[144:147], a[0:3]
  s_add_u32 s14, s96, 29184
  buffer_load_dwordx4 v[128:131], v25, s[64:67], s14 offen sc1
  v_mul_f32 v52, v0, v84
  v_mul_f32 v53, v0, v85
  v_mfma_f32_16x16x32_bf16 a[16:19], a[80:83], v[148:151], a[16:19]
  v_mul_f32 v76, v0, v92
  v_mul_f32 v77, v0, v93
  v_mfma_f32_16x16x32_bf16 a[32:35], a[80:83], v[152:155], a[32:35]
  buffer_load_dwordx4 v[132:135], v26, s[64:67], s14 offen sc1
  v_exp_f32 v52, v52
  v_exp_f32 v53, v53
  v_mfma_f32_16x16x32_bf16 a[48:51], a[80:83], v[156:159], a[48:51]
  v_fract_f32 v76, v76
  v_fract_f32 v77, v77
  ds_read_b64_tr_b16 a[80:81], v21 offset:8192
  s_add_u32 s14, s97, 29184
  buffer_load_dwordx4 v[136:139], v25, s[64:67], s14 offen sc1
  ds_read_b64_tr_b16 a[82:83], v21 offset:10240
  v_cos_f32 v68, v76
  v_cos_f32 v69, v77
  v_mfma_f32_16x16x32_bf16 a[4:7], a[84:87], v[144:147], a[4:7]
  v_sin_f32 v76, v76
  buffer_load_dwordx4 v[140:143], v26, s[64:67], s14 offen sc1
  v_sin_f32 v77, v77
  v_mfma_f32_16x16x32_bf16 a[20:23], a[84:87], v[148:151], a[20:23]
  v_mul_f32 v68, v52, v68
  v_mul_f32 v69, v53, v69
  v_mfma_f32_16x16x32_bf16 a[36:39], a[84:87], v[152:155], a[36:39]
  v_mul_f32 v76, v52, v76
  v_mul_f32 v77, v53, v77
  v_mfma_f32_16x16x32_bf16 a[52:55], a[84:87], v[156:159], a[52:55]
  v_mul_f32 v52, v0, v86
  v_mul_f32 v53, v0, v87
  ds_read_b64_tr_b16 a[84:85], v22 offset:8192
  ds_read_b64_tr_b16 a[86:87], v22 offset:10240
  v_mfma_f32_16x16x32_bf16 a[8:11], a[88:91], v[144:147], a[8:11]
  v_mul_f32 v78, v0, v94
  v_mul_f32 v79, v0, v95
  v_mfma_f32_16x16x32_bf16 a[24:27], a[88:91], v[148:151], a[24:27]
  v_exp_f32 v52, v52
  v_exp_f32 v53, v53
  v_mfma_f32_16x16x32_bf16 a[40:43], a[88:91], v[152:155], a[40:43]
  v_fract_f32 v78, v78
  v_fract_f32 v79, v79
  v_mfma_f32_16x16x32_bf16 a[56:59], a[88:91], v[156:159], a[56:59]
  v_cos_f32 v70, v78
  v_cos_f32 v71, v79
  ds_read_b64_tr_b16 a[88:89], v23 offset:8192
  ds_read_b64_tr_b16 a[90:91], v23 offset:10240
  v_sin_f32 v78, v78
  v_sin_f32 v79, v79
  v_mfma_f32_16x16x32_bf16 a[12:15], a[92:95], v[144:147], a[12:15]
  v_mul_f32 v70, v52, v70
  v_mul_f32 v71, v53, v71
  v_mfma_f32_16x16x32_bf16 a[28:31], a[92:95], v[148:151], a[28:31]
  v_mul_f32 v78, v52, v78
  v_mul_f32 v79, v53, v79
  v_mfma_f32_16x16x32_bf16 a[44:47], a[92:95], v[152:155], a[44:47]
  v_mfma_f32_16x16x32_bf16 a[60:63], a[92:95], v[156:159], a[60:63]
  ds_read_b64_tr_b16 a[92:93], v24 offset:8192
  ds_read_b64_tr_b16 a[94:95], v24 offset:10240
  s_waitcnt vmcnt(28)
  v_mfma_f32_16x16x32_bf16 a[0:3], a[96:99], v[160:163], a[0:3]
  buffer_load_dwordx4 v[80:83], v4, s[64:67], s13 offen sc1
  v_mfma_f32_16x16x32_bf16 a[16:19], a[96:99], v[164:167], a[16:19]
  v_mfma_f32_16x16x32_bf16 a[32:35], a[96:99], v[168:171], a[32:35]
  v_mfma_f32_16x16x32_bf16 a[48:51], a[96:99], v[172:175], a[48:51]
  buffer_load_dwordx4 v[84:87], v5, s[64:67], s13 offen sc1
  ds_read_b64_tr_b16 a[96:97], v21 offset:12288
  ds_read_b64_tr_b16 a[98:99], v21 offset:14336
  v_mfma_f32_16x16x32_bf16 a[4:7], a[100:103], v[160:163], a[4:7]
  v_mfma_f32_16x16x32_bf16 a[20:23], a[100:103], v[164:167], a[20:23]
  v_mfma_f32_16x16x32_bf16 a[36:39], a[100:103], v[168:171], a[36:39]
  buffer_load_dwordx4 v[88:91], v6, s[64:67], s13 offen sc1
  v_mfma_f32_16x16x32_bf16 a[52:55], a[100:103], v[172:175], a[52:55]
  ds_read_b64_tr_b16 a[100:101], v22 offset:12288
  ds_read_b64_tr_b16 a[102:103], v22 offset:14336
  v_mfma_f32_16x16x32_bf16 a[8:11], a[104:107], v[160:163], a[8:11]
  v_mfma_f32_16x16x32_bf16 a[24:27], a[104:107], v[164:167], a[24:27]
  buffer_load_dwordx4 v[92:95], v7, s[64:67], s13 offen sc1
  v_mfma_f32_16x16x32_bf16 a[40:43], a[104:107], v[168:171], a[40:43]
  v_mfma_f32_16x16x32_bf16 a[56:59], a[104:107], v[172:175], a[56:59]
  ds_read_b64_tr_b16 a[104:105], v23 offset:12288
  ds_read_b64_tr_b16 a[106:107], v23 offset:14336
  v_mfma_f32_16x16x32_bf16 a[12:15], a[108:111], v[160:163], a[12:15]
  v_mfma_f32_16x16x32_bf16 a[28:31], a[108:111], v[164:167], a[28:31]
  v_mfma_f32_16x16x32_bf16 a[44:47], a[108:111], v[168:171], a[44:47]
  v_mfma_f32_16x16x32_bf16 a[60:63], a[108:111], v[172:175], a[60:63]
  ds_read_b64_tr_b16 a[108:109], v24 offset:12288
  ds_read_b64_tr_b16 a[110:111], v24 offset:14336
  s_waitcnt vmcnt(28)
  v_mfma_f32_16x16x32_bf16 a[0:3], a[112:115], v[176:179], a[0:3]
  buffer_load_dwordx4 v[44:47], v8, s[64:67], s13 offen sc1
  v_mfma_f32_16x16x32_bf16 a[16:19], a[112:115], v[180:183], a[16:19]
  v_mfma_f32_16x16x32_bf16 a[32:35], a[112:115], v[184:187], a[32:35]
  v_mfma_f32_16x16x32_bf16 a[48:51], a[112:115], v[188:191], a[48:51]
  buffer_load_dwordx4 v[56:59], v9, s[64:67], s13 offen sc1
  ds_read_b64_tr_b16 a[112:113], v21 offset:16384
  ds_read_b64_tr_b16 a[114:115], v21 offset:18432
  v_mfma_f32_16x16x32_bf16 a[4:7], a[116:119], v[176:179], a[4:7]
  v_mfma_f32_16x16x32_bf16 a[20:23], a[116:119], v[180:183], a[20:23]
  v_mfma_f32_16x16x32_bf16 a[36:39], a[116:119], v[184:187], a[36:39]
  buffer_load_dwordx4 v[12:15], v10, s[64:67], s13 offen sc1
  v_mfma_f32_16x16x32_bf16 a[52:55], a[116:119], v[188:191], a[52:55]
  ds_read_b64_tr_b16 a[116:117], v22 offset:16384
  ds_read_b64_tr_b16 a[118:119], v22 offset:18432
  v_mfma_f32_16x16x32_bf16 a[8:11], a[120:123], v[176:179], a[8:11]
  v_mfma_f32_16x16x32_bf16 a[24:27], a[120:123], v[180:183], a[24:27]
  buffer_load_dwordx4 v[30:33], v11, s[64:67], s13 offen sc1
  v_mfma_f32_16x16x32_bf16 a[40:43], a[120:123], v[184:187], a[40:43]
  v_mfma_f32_16x16x32_bf16 a[56:59], a[120:123], v[188:191], a[56:59]
  ds_read_b64_tr_b16 a[120:121], v23 offset:16384
  ds_read_b64_tr_b16 a[122:123], v23 offset:18432
  v_mfma_f32_16x16x32_bf16 a[12:15], a[124:127], v[176:179], a[12:15]
  v_mfma_f32_16x16x32_bf16 a[28:31], a[124:127], v[180:183], a[28:31]
  v_mfma_f32_16x16x32_bf16 a[44:47], a[124:127], v[184:187], a[44:47]
  v_mfma_f32_16x16x32_bf16 a[60:63], a[124:127], v[188:191], a[60:63]
  ds_read_b64_tr_b16 a[124:125], v24 offset:16384
  ds_read_b64_tr_b16 a[126:127], v24 offset:18432
  s_waitcnt vmcnt(28)
  s_waitcnt lgkmcnt(15)
  v_mfma_f32_16x16x32_bf16 a[0:3], a[64:67], v[192:195], a[0:3]
  s_add_u32 s14, s96, 31232
  buffer_load_dwordx4 v[144:147], v25, s[64:67], s14 offen sc1
  v_mfma_f32_16x16x32_bf16 a[16:19], a[64:67], v[196:199], a[16:19]
  v_mfma_f32_16x16x32_bf16 a[32:35], a[64:67], v[200:203], a[32:35]
  v_mfma_f32_16x16x32_bf16 a[48:51], a[64:67], v[204:207], a[48:51]
  buffer_load_dwordx4 v[148:151], v26, s[64:67], s14 offen sc1
  ds_read_b64_tr_b16 a[64:65], v21 offset:20480
  ds_read_b64_tr_b16 a[66:67], v21 offset:22528
  v_mfma_f32_16x16x32_bf16 a[4:7], a[68:71], v[192:195], a[4:7]
  v_mfma_f32_16x16x32_bf16 a[20:23], a[68:71], v[196:199], a[20:23]
  v_mfma_f32_16x16x32_bf16 a[36:39], a[68:71], v[200:203], a[36:39]
  s_add_u32 s14, s97, 31232
  buffer_load_dwordx4 v[152:155], v25, s[64:67], s14 offen sc1
  v_mfma_f32_16x16x32_bf16 a[52:55], a[68:71], v[204:207], a[52:55]
  ds_read_b64_tr_b16 a[68:69], v22 offset:20480
  ds_read_b64_tr_b16 a[70:71], v22 offset:22528
  v_mfma_f32_16x16x32_bf16 a[8:11], a[72:75], v[192:195], a[8:11]
  v_mfma_f32_16x16x32_bf16 a[24:27], a[72:75], v[196:199], a[24:27]
  buffer_load_dwordx4 v[156:159], v26, s[64:67], s14 offen sc1
  v_mfma_f32_16x16x32_bf16 a[40:43], a[72:75], v[200:203], a[40:43]
  v_mfma_f32_16x16x32_bf16 a[56:59], a[72:75], v[204:207], a[56:59]
  ds_read_b64_tr_b16 a[72:73], v23 offset:20480
  ds_read_b64_tr_b16 a[74:75], v23 offset:22528
  v_mfma_f32_16x16x32_bf16 a[12:15], a[76:79], v[192:195], a[12:15]
  s_add_u32 s14, s96, 38656
  buffer_load_dwordx4 v[160:163], v25, s[64:67], s14 offen sc1
  v_mfma_f32_16x16x32_bf16 a[28:31], a[76:79], v[196:199], a[28:31]
  v_mfma_f32_16x16x32_bf16 a[44:47], a[76:79], v[200:203], a[44:47]
  v_mfma_f32_16x16x32_bf16 a[60:63], a[76:79], v[204:207], a[60:63]
  buffer_load_dwordx4 v[164:167], v26, s[64:67], s14 offen sc1
  ds_read_b64_tr_b16 a[76:77], v24 offset:20480
  ds_read_b64_tr_b16 a[78:79], v24 offset:22528
  s_add_u32 s14, s97, 38656
  buffer_load_dwordx4 v[168:171], v25, s[64:67], s14 offen sc1
  buffer_load_dwordx4 v[172:175], v26, s[64:67], s14 offen sc1
  s_add_u32 s14, s96, 40704
  buffer_load_dwordx4 v[176:179], v25, s[64:67], s14 offen sc1
  buffer_load_dwordx4 v[180:183], v26, s[64:67], s14 offen sc1
  s_add_u32 s14, s97, 40704
  buffer_load_dwordx4 v[184:187], v25, s[64:67], s14 offen sc1
  buffer_load_dwordx4 v[188:191], v26, s[64:67], s14 offen sc1
  s_waitcnt vmcnt(12)
  s_mov_b32 s51, 0
Llb:
  s_mov_b64 s[92:93], 0
  v_cmp_ne_u64 vcc, v[82:83], v[54:55]
  v_cmp_ne_u32 s[94:95], v19, v4
  s_nop 0
  s_and_b64 vcc, vcc, s[94:95]
  s_or_b64 s[92:93], s[92:93], vcc
  v_cmp_ne_u64 vcc, v[86:87], v[54:55]
  v_cmp_ne_u32 s[94:95], v19, v5
  s_nop 0
  s_and_b64 vcc, vcc, s[94:95]
  s_or_b64 s[92:93], s[92:93], vcc
  v_cmp_ne_u64 vcc, v[90:91], v[54:55]
  v_cmp_ne_u32 s[94:95], v19, v6
  s_nop 0
  s_and_b64 vcc, vcc, s[94:95]
  s_or_b64 s[92:93], s[92:93], vcc
  v_cmp_ne_u64 vcc, v[94:95], v[54:55]
  v_cmp_ne_u32 s[94:95], v19, v7
  s_nop 0
  s_and_b64 vcc, vcc, s[94:95]
  s_or_b64 s[92:93], s[92:93], vcc
  v_cmp_ne_u64 vcc, v[46:47], v[54:55]
  v_cmp_ne_u32 s[94:95], v19, v8
  s_nop 0
  s_and_b64 vcc, vcc, s[94:95]
  s_or_b64 s[92:93], s[92:93], vcc
  v_cmp_ne_u64 vcc, v[58:59], v[54:55]
  v_cmp_ne_u32 s[94:95], v19, v9
  s_nop 0
  s_and_b64 vcc, vcc, s[94:95]
  s_or_b64 s[92:93], s[92:93], vcc
  v_cmp_ne_u64 vcc, v[14:15], v[54:55]
  v_cmp_ne_u32 s[94:95], v19, v10
  s_nop 0
  s_and_b64 vcc, vcc, s[94:95]
  s_or_b64 s[92:93], s[92:93], vcc
  v_cmp_ne_u64 vcc, v[32:33], v[54:55]
  v_cmp_ne_u32 s[94:95], v19, v11
  s_nop 0
  s_and_b64 vcc, vcc, s[94:95]
  s_or_b64 s[92:93], s[92:93], vcc
  s_cmp_eq_u64 s[92:93], 0
  s_cbranch_scc1 Llbok
  buffer_load_dwordx4 v[80:83], v4, s[64:67], s13 offen sc1
  buffer_load_dwordx4 v[84:87], v5, s[64:67], s13 offen sc1
  buffer_load_dwordx4 v[88:91], v6, s[64:67], s13 offen sc1
  buffer_load_dwordx4 v[92:95], v7, s[64:67], s13 offen sc1
  buffer_load_dwordx4 v[44:47], v8, s[64:67], s13 offen sc1
  buffer_load_dwordx4 v[56:59], v9, s[64:67], s13 offen sc1
  buffer_load_dwordx4 v[12:15], v10, s[64:67], s13 offen sc1
  buffer_load_dwordx4 v[30:33], v11, s[64:67], s13 offen sc1
  s_add_u32 s51, s51, 1
  s_waitcnt vmcnt(0)
  s_cmp_lt_u32 s51, 0x40000
  s_cbranch_scc1 Llb
Llbok:
  s_add_u32 m0, s8, 24576
  s_add_u32 s14, s9, 327680
  buffer_load_dwordx4 v20, s[76:79], s14 offen offset:0 lds
  v_fma_f32 v12, v30, v18, v12
  v_fma_f32 v13, v30, v38, v13
  v_fma_f32 v12, -v31, v38, v12
  v_fma_f32 v13, v31, v18, v13
  v_fma_f32 v56, v12, v18, v56
  v_fma_f32 v57, v12, v38, v57
  v_fma_f32 v56, -v13, v38, v56
  v_fma_f32 v57, v13, v18, v57
  v_fma_f32 v44, v56, v18, v44
  v_fma_f32 v45, v56, v38, v45
  v_fma_f32 v44, -v57, v38, v44
  v_fma_f32 v45, v57, v18, v45
  v_fma_f32 v92, v44, v18, v92
  v_fma_f32 v93, v44, v38, v93
  v_fma_f32 v92, -v45, v38, v92
  v_fma_f32 v93, v45, v18, v93
  buffer_load_dwordx4 v41, s[76:79], s14 offen offset:1024 lds
  v_fma_f32 v88, v92, v18, v88
  v_fma_f32 v89, v92, v38, v89
  v_fma_f32 v88, -v93, v38, v88
  v_fma_f32 v89, v93, v18, v89
  v_fma_f32 v84, v88, v18, v84
  v_fma_f32 v85, v88, v38, v85
  v_fma_f32 v84, -v89, v38, v84
  v_fma_f32 v85, v89, v18, v85
  v_fma_f32 v80, v84, v18, v80
  v_fma_f32 v81, v84, v38, v81
  v_fma_f32 v80, -v85, v38, v80
  v_fma_f32 v81, v85, v18, v81
  ds_read_b128 v[44:47], v60 offset:29696
  ds_read_b128 v[56:59], v60 offset:29712
  ds_read_b128 v[12:15], v60 offset:29824
  ds_read_b128 v[4:7], v60 offset:29840
  s_add_u32 s14, s9, 440320
  buffer_load_dwordx4 v20, s[76:79], s14 offen offset:2048 lds
  v_mov_b32 v82, v80
  v_mov_b32 v83, v81
  s_nop 0
  v_permlane32_swap_b32 v80, v82
  v_permlane32_swap_b32 v81, v83
  v_fma_f32 v80, v82, v35, v80
  v_fma_f32 v81, v82, v36, v81
  v_fma_f32 v80, -v83, v36, v80
  v_fma_f32 v81, v83, v35, v81
  v_fma_f32 v16, v80, v39, v16
  v_fma_f32 v17, v80, v40, v17
  v_fma_f32 v16, -v81, v40, v16
  v_fma_f32 v17, v81, v39, v17
  ds_write_b32 v43, v16 offset:32256
  ds_write_b32 v43, v17 offset:32384
  s_waitcnt lgkmcnt(0)
  ds_read_b128 v[80:83], v60 offset:32256
  ds_read_b128 v[84:87], v60 offset:32272
  buffer_load_dwordx4 v41, s[76:79], s14 offen offset:3072 lds
  ds_read_b128 v[88:91], v60 offset:32384
  ds_read_b128 v[92:95], v60 offset:32400
  s_waitcnt lgkmcnt(0)
  v_fma_f32 v100, v80, v64, v100
  v_fma_f32 v116, v80, v72, v116
  v_fma_f32 v100, -v88, v72, v100
  v_fma_f32 v116, v88, v64, v116
  v_fma_f32 v101, v81, v65, v101
  v_fma_f32 v117, v81, v73, v117
  v_fma_f32 v101, -v89, v73, v101
  v_fma_f32 v117, v89, v65, v117
  v_fma_f32 v102, v82, v66, v102
  v_fma_f32 v118, v82, v74, v118
  v_fma_f32 v102, -v90, v74, v102
  v_fma_f32 v118, v90, v66, v118
  v_fma_f32 v103, v83, v67, v103
  v_lshrrev_b32 v52, 3, v1
  v_and_b32 v53, 7, v1
  v_lshlrev_b32 v53, 4, v53
  v_lshl_add_u32 v52, v52, 11, v53
  s_lshl_b32 s50, s6, 1
  s_add_u32 s50, s50, s99
  s_lshl_b32 s50, s50, 5
  s_add_u32 s50, s50, s98
  s_lshl_b32 s50, s50, 3
  s_add_u32 s50, s50, s7
  s_lshl_b32 s50, s50, 7
  s_add_u32 m0, s8, 8192
  s_nop 0
  buffer_load_dwordx4 v52, s[52:55], s50 offen lds
  v_fma_f32 v119, v83, v75, v119
  v_fma_f32 v103, -v91, v75, v103
  v_fma_f32 v119, v91, v67, v119
  v_fma_f32 v108, v84, v68, v108
  v_fma_f32 v124, v84, v76, v124
  v_fma_f32 v108, -v92, v76, v108
  v_fma_f32 v124, v92, v68, v124
  v_fma_f32 v109, v85, v69, v109
  v_fma_f32 v125, v85, v77, v125
  v_fma_f32 v109, -v93, v77, v109
  v_fma_f32 v125, v93, v69, v125
  v_fma_f32 v110, v86, v70, v110
  v_fma_f32 v126, v86, v78, v126
  v_fma_f32 v110, -v94, v78, v110
  v_fma_f32 v126, v94, v70, v126
  v_fma_f32 v111, v87, v71, v111
  s_add_u32 s50, s50, 16384
  s_add_u32 m0, m0, 1024
  s_nop 0
  buffer_load_dwordx4 v52, s[52:55], s50 offen lds
  v_fma_f32 v127, v87, v79, v127
  v_fma_f32 v111, -v95, v79, v111
  v_fma_f32 v127, v95, v71, v127
  v_mov_b32_dpp v80, v100 row_shr:1 row_mask:0xf bank_mask:0xf
  v_mov_b32_dpp v88, v116 row_shr:1 row_mask:0xf bank_mask:0xf
  v_mov_b32_dpp v81, v101 row_shr:1 row_mask:0xf bank_mask:0xf
  v_mov_b32_dpp v89, v117 row_shr:1 row_mask:0xf bank_mask:0xf
  v_mov_b32_dpp v82, v102 row_shr:1 row_mask:0xf bank_mask:0xf
  v_mov_b32_dpp v90, v118 row_shr:1 row_mask:0xf bank_mask:0xf
  v_mov_b32_dpp v83, v103 row_shr:1 row_mask:0xf bank_mask:0xf
  v_mov_b32_dpp v91, v119 row_shr:1 row_mask:0xf bank_mask:0xf
  v_mov_b32_dpp v84, v108 row_shr:1 row_mask:0xf bank_mask:0xf
  v_mov_b32_dpp v92, v124 row_shr:1 row_mask:0xf bank_mask:0xf
  v_mov_b32_dpp v85, v109 row_shr:1 row_mask:0xf bank_mask:0xf
  v_mov_b32_dpp v93, v125 row_shr:1 row_mask:0xf bank_mask:0xf
  v_mov_b32_dpp v86, v110 row_shr:1 row_mask:0xf bank_mask:0xf
  v_and_b32 v53, 31, v1
  s_lshl_b32 s50, s7, 7
  v_lshl_add_u32 v53, v53, 2, s50
  s_add_u32 m0, m0, 1024
  s_nop 0
  global_load_lds_dword v53, s[32:33]
  s_add_u32 m0, m0, 256
  s_nop 0
  global_load_lds_dword v53, s[42:43]
  v_mov_b32_dpp v94, v126 row_shr:1 row_mask:0xf bank_mask:0xf
  v_mov_b32_dpp v87, v111 row_shr:1 row_mask:0xf bank_mask:0xf
  v_mov_b32_dpp v95, v127 row_shr:1 row_mask:0xf bank_mask:0xf
  v_cvt_pk_bf16_f32 v100, v100, v101
  v_cvt_pk_bf16_f32 v101, v102, v103
  v_cvt_pk_bf16_f32 v102, v108, v109
  v_cvt_pk_bf16_f32 v103, v110, v111
  v_min_u32 v100, -2, v100
  buffer_store_dwordx4 v[100:103], v29, s[64:67], s100 offen offset:1024 sc1
  v_cvt_pk_bf16_f32 v116, -v116, -v117
  v_cvt_pk_bf16_f32 v117, -v118, -v119
  v_cvt_pk_bf16_f32 v118, -v124, -v125
  v_cvt_pk_bf16_f32 v119, -v126, -v127
  v_min_u32 v116, -2, v116
  buffer_store_dwordx4 v[116:119], v29, s[64:67], s100 offen offset:3072 sc1
  v_fma_f32 v96, v80, v44, v96
  v_fma_f32 v112, v80, v12, v112
  v_fma_f32 v96, -v88, v12, v96
  v_fma_f32 v112, v88, v44, v112
  v_fma_f32 v97, v81, v45, v97
  v_fma_f32 v113, v81, v13, v113
  v_fma_f32 v97, -v89, v13, v97
  v_fma_f32 v113, v89, v45, v113
  v_fma_f32 v98, v82, v46, v98
  v_fma_f32 v114, v82, v14, v114
  v_fma_f32 v98, -v90, v14, v98
  v_fma_f32 v114, v90, v46, v114
  v_fma_f32 v99, v83, v47, v99
  v_fma_f32 v115, v83, v15, v115
  v_fma_f32 v99, -v91, v15, v99
  v_fma_f32 v115, v91, v47, v115
  v_fma_f32 v104, v84, v56, v104
  v_fma_f32 v120, v84, v4, v120
  v_fma_f32 v104, -v92, v4, v104
  v_fma_f32 v120, v92, v56, v120
  v_fma_f32 v105, v85, v57, v105
  v_fma_f32 v121, v85, v5, v121
  v_fma_f32 v105, -v93, v5, v105
  s_add_u32 s14, s96, 42752
  buffer_load_dwordx4 v[192:195], v25, s[64:67], s14 offen sc1
  v_fma_f32 v121, v93, v57, v121
  v_fma_f32 v106, v86, v58, v106
  v_fma_f32 v122, v86, v6, v122
  v_fma_f32 v106, -v94, v6, v106
  v_fma_f32 v122, v94, v58, v122
  v_fma_f32 v107, v87, v59, v107
  v_fma_f32 v123, v87, v7, v123
  v_fma_f32 v107, -v95, v7, v107
  v_fma_f32 v123, v95, v59, v123
  v_cvt_pk_bf16_f32 v96, v96, v97
  v_cvt_pk_bf16_f32 v97, v98, v99
  v_cvt_pk_bf16_f32 v98, v104, v105
  v_cvt_pk_bf16_f32 v99, v106, v107
  v_min_u32 v96, -2, v96
  buffer_store_dwordx4 v[96:99], v29, s[64:67], s100 offen offset:0 sc1
  v_cvt_pk_bf16_f32 v112, -v112, -v113
  v_cvt_pk_bf16_f32 v113, -v114, -v115
  v_cvt_pk_bf16_f32 v114, -v120, -v121
  v_cvt_pk_bf16_f32 v115, -v122, -v123
  v_min_u32 v112, -2, v112
  buffer_store_dwordx4 v[112:115], v29, s[64:67], s100 offen offset:2048 sc1
  buffer_load_dwordx4 v[196:199], v26, s[64:67], s14 offen sc1
  s_add_u32 s14, s97, 42752
  buffer_load_dwordx4 v[200:203], v25, s[64:67], s14 offen sc1
  buffer_load_dwordx4 v[204:207], v26, s[64:67], s14 offen sc1
  s_lshl_b32 s15, s6, 6
  s_lshl_b32 s51, s99, 5
  s_add_u32 s15, s15, s51
  s_add_u32 s15, s15, s98
  v_lshl_add_u32 v4, v3, 1, s15
  s_lshl_b32 s15, s7, 7
  v_lshl_add_u32 v5, v2, 3, s15
  v_lshl_add_u32 v40, v4, 10, v5
  v_lshlrev_b32 v6, 4, v2
  s_lshl_b32 s15, s98, 3
  s_add_u32 s15, s15, s96
  s_add_u32 s15, s15, 11264
  v_lshlrev_b32 v5, 3, v3
  v_add_u32 v5, s8, v5
  v_lshl_add_u32 v4, v2, 7, v5
  v_mfma_f32_16x16x32_bf16 a[0:3], a[80:83], v[208:211], a[0:3]
  buffer_load_dwordx2 v[88:89], v6, s[64:67], s15 offen sc1
  v_mfma_f32_16x16x32_bf16 a[16:19], a[80:83], v[212:215], a[16:19]
  v_mfma_f32_16x16x32_bf16 a[32:35], a[80:83], v[216:219], a[32:35]
  v_mfma_f32_16x16x32_bf16 a[48:51], a[80:83], v[220:223], a[48:51]
  ds_read_b64_tr_b16 a[80:81], v21 offset:0
  ds_read_b64_tr_b16 a[82:83], v21 offset:2048
  v_mfma_f32_16x16x32_bf16 a[4:7], a[84:87], v[208:211], a[4:7]
  v_mfma_f32_16x16x32_bf16 a[20:23], a[84:87], v[212:215], a[20:23]
  v_mfma_f32_16x16x32_bf16 a[36:39], a[84:87], v[216:219], a[36:39]
  v_mfma_f32_16x16x32_bf16 a[52:55], a[84:87], v[220:223], a[52:55]
  ds_read_b64_tr_b16 a[84:85], v22 offset:0
  ds_read_b64_tr_b16 a[86:87], v22 offset:2048
  v_mfma_f32_16x16x32_bf16 a[8:11], a[88:91], v[208:211], a[8:11]
  v_mfma_f32_16x16x32_bf16 a[24:27], a[88:91], v[212:215], a[24:27]
  v_mfma_f32_16x16x32_bf16 a[40:43], a[88:91], v[216:219], a[40:43]
  v_mfma_f32_16x16x32_bf16 a[56:59], a[88:91], v[220:223], a[56:59]
  ds_read_b64_tr_b16 a[88:89], v23 offset:0
  ds_read_b64_tr_b16 a[90:91], v23 offset:2048
  v_mfma_f32_16x16x32_bf16 a[12:15], a[92:95], v[208:211], a[12:15]
  v_mfma_f32_16x16x32_bf16 a[28:31], a[92:95], v[212:215], a[28:31]
  v_mfma_f32_16x16x32_bf16 a[44:47], a[92:95], v[216:219], a[44:47]
  v_mfma_f32_16x16x32_bf16 a[60:63], a[92:95], v[220:223], a[60:63]
  ds_read_b64_tr_b16 a[92:93], v24 offset:0
  ds_read_b64_tr_b16 a[94:95], v24 offset:2048
  v_mfma_f32_16x16x32_bf16 a[0:3], a[96:99], v[224:227], a[0:3]
  s_add_u32 s14, s96, 33280
  buffer_load_dwordx2 v[208:209], v27, s[64:67], s14 offen sc1
  buffer_load_dwordx2 v[212:213], v28, s[64:67], s14 offen sc1
  v_mfma_f32_16x16x32_bf16 a[16:19], a[96:99], v[228:231], a[16:19]
  v_mfma_f32_16x16x32_bf16 a[32:35], a[96:99], v[232:235], a[32:35]
  v_mfma_f32_16x16x32_bf16 a[48:51], a[96:99], v[236:239], a[48:51]
  s_add_u32 s14, s96, 44800
  buffer_load_dwordx2 v[210:211], v27, s[64:67], s14 offen sc1
  buffer_load_dwordx2 v[214:215], v28, s[64:67], s14 offen sc1
  ds_read_b64_tr_b16 a[96:97], v21 offset:4096
  ds_read_b64_tr_b16 a[98:99], v21 offset:6144
  v_mfma_f32_16x16x32_bf16 a[4:7], a[100:103], v[224:227], a[4:7]
  v_mfma_f32_16x16x32_bf16 a[20:23], a[100:103], v[228:231], a[20:23]
  v_mfma_f32_16x16x32_bf16 a[36:39], a[100:103], v[232:235], a[36:39]
  s_add_u32 s14, s97, 33280
  buffer_load_dwordx2 v[216:217], v27, s[64:67], s14 offen sc1
  buffer_load_dwordx2 v[220:221], v28, s[64:67], s14 offen sc1
  v_mfma_f32_16x16x32_bf16 a[52:55], a[100:103], v[236:239], a[52:55]
  ds_read_b64_tr_b16 a[100:101], v22 offset:4096
  ds_read_b64_tr_b16 a[102:103], v22 offset:6144
  v_mfma_f32_16x16x32_bf16 a[8:11], a[104:107], v[224:227], a[8:11]
  v_mfma_f32_16x16x32_bf16 a[24:27], a[104:107], v[228:231], a[24:27]
  s_add_u32 s14, s97, 44800
  buffer_load_dwordx2 v[218:219], v27, s[64:67], s14 offen sc1
  buffer_load_dwordx2 v[222:223], v28, s[64:67], s14 offen sc1
  v_mfma_f32_16x16x32_bf16 a[40:43], a[104:107], v[232:235], a[40:43]
  v_mfma_f32_16x16x32_bf16 a[56:59], a[104:107], v[236:239], a[56:59]
  ds_read_b64_tr_b16 a[104:105], v23 offset:4096
  ds_read_b64_tr_b16 a[106:107], v23 offset:6144
  v_mfma_f32_16x16x32_bf16 a[12:15], a[108:111], v[224:227], a[12:15]
  v_mfma_f32_16x16x32_bf16 a[28:31], a[108:111], v[228:231], a[28:31]
  v_mfma_f32_16x16x32_bf16 a[44:47], a[108:111], v[232:235], a[44:47]
  v_mfma_f32_16x16x32_bf16 a[60:63], a[108:111], v[236:239], a[60:63]
  ds_read_b64_tr_b16 a[108:109], v24 offset:4096
  ds_read_b64_tr_b16 a[110:111], v24 offset:6144
  v_mfma_f32_16x16x32_bf16 a[0:3], a[112:115], v[240:243], a[0:3]
  v_mfma_f32_16x16x32_bf16 a[16:19], a[112:115], v[244:247], a[16:19]
  v_mfma_f32_16x16x32_bf16 a[32:35], a[112:115], v[248:251], a[32:35]
  v_mfma_f32_16x16x32_bf16 a[48:51], a[112:115], v[252:255], a[48:51]
  ds_read_b64_tr_b16 a[112:113], v48 offset:0
  ds_read_b64_tr_b16 a[114:115], v48 offset:2048
  v_mfma_f32_16x16x32_bf16 a[4:7], a[116:119], v[240:243], a[4:7]
  v_mfma_f32_16x16x32_bf16 a[20:23], a[116:119], v[244:247], a[20:23]
  v_mfma_f32_16x16x32_bf16 a[36:39], a[116:119], v[248:251], a[36:39]
  v_mfma_f32_16x16x32_bf16 a[52:55], a[116:119], v[252:255], a[52:55]
  ds_read_b64_tr_b16 a[116:117], v49 offset:0
  ds_read_b64_tr_b16 a[118:119], v49 offset:2048
  v_mfma_f32_16x16x32_bf16 a[8:11], a[120:123], v[240:243], a[8:11]
  v_mfma_f32_16x16x32_bf16 a[24:27], a[120:123], v[244:247], a[24:27]
  v_mfma_f32_16x16x32_bf16 a[40:43], a[120:123], v[248:251], a[40:43]
  v_mfma_f32_16x16x32_bf16 a[56:59], a[120:123], v[252:255], a[56:59]
  ds_read_b64_tr_b16 a[120:121], v50 offset:0
  ds_read_b64_tr_b16 a[122:123], v50 offset:2048
  v_mfma_f32_16x16x32_bf16 a[12:15], a[124:127], v[240:243], a[12:15]
  v_mfma_f32_16x16x32_bf16 a[28:31], a[124:127], v[244:247], a[28:31]
  v_mfma_f32_16x16x32_bf16 a[44:47], a[124:127], v[248:251], a[44:47]
  v_mfma_f32_16x16x32_bf16 a[60:63], a[124:127], v[252:255], a[60:63]
  ds_read_b64_tr_b16 a[124:125], v51 offset:0
  ds_read_b64_tr_b16 a[126:127], v51 offset:2048
  v_mfma_f32_16x16x32_bf16 a[0:3], a[64:67], v[128:131], a[0:3]
  s_add_u32 s14, s96, 0
  buffer_load_dwordx4 v[224:227], v25, s[64:67], s14 offen sc1
  v_mfma_f32_16x16x32_bf16 a[16:19], a[64:67], v[132:135], a[16:19]
  v_mfma_f32_16x16x32_bf16 a[32:35], a[64:67], v[136:139], a[32:35]
  v_mfma_f32_16x16x32_bf16 a[48:51], a[64:67], v[140:143], a[48:51]
  buffer_load_dwordx4 v[228:231], v26, s[64:67], s14 offen sc1
  ds_read_b64_tr_b16 a[64:65], v48 offset:4096
  ds_read_b64_tr_b16 a[66:67], v48 offset:6144
  v_mfma_f32_16x16x32_bf16 a[4:7], a[68:71], v[128:131], a[4:7]
  v_mfma_f32_16x16x32_bf16 a[20:23], a[68:71], v[132:135], a[20:23]
  v_mfma_f32_16x16x32_bf16 a[36:39], a[68:71], v[136:139], a[36:39]
  s_add_u32 s14, s97, 0
  buffer_load_dwordx4 v[232:235], v25, s[64:67], s14 offen sc1
  v_mfma_f32_16x16x32_bf16 a[52:55], a[68:71], v[140:143], a[52:55]
  ds_read_b64_tr_b16 a[68:69], v49 offset:4096
  ds_read_b64_tr_b16 a[70:71], v49 offset:6144
  v_mfma_f32_16x16x32_bf16 a[8:11], a[72:75], v[128:131], a[8:11]
  v_mfma_f32_16x16x32_bf16 a[24:27], a[72:75], v[132:135], a[24:27]
  buffer_load_dwordx4 v[236:239], v26, s[64:67], s14 offen sc1
  v_mfma_f32_16x16x32_bf16 a[40:43], a[72:75], v[136:139], a[40:43]
  v_mfma_f32_16x16x32_bf16 a[56:59], a[72:75], v[140:143], a[56:59]
  ds_read_b64_tr_b16 a[72:73], v50 offset:4096
  ds_read_b64_tr_b16 a[74:75], v50 offset:6144
  v_mfma_f32_16x16x32_bf16 a[12:15], a[76:79], v[128:131], a[12:15]
  v_mfma_f32_16x16x32_bf16 a[28:31], a[76:79], v[132:135], a[28:31]
  v_mfma_f32_16x16x32_bf16 a[44:47], a[76:79], v[136:139], a[44:47]
  v_mfma_f32_16x16x32_bf16 a[60:63], a[76:79], v[140:143], a[60:63]
  ds_read_b64_tr_b16 a[76:77], v51 offset:4096
  ds_read_b64_tr_b16 a[78:79], v51 offset:6144
  s_waitcnt vmcnt(37)
  s_waitcnt vmcnt(25)
  s_waitcnt lgkmcnt(15)
  v_mfma_f32_16x16x32_bf16 a[0:3], a[80:83], v[144:147], a[0:3]
  s_add_u32 s14, s96, 2048
  buffer_load_dwordx4 v[240:243], v25, s[64:67], s14 offen sc1
  v_mfma_f32_16x16x32_bf16 a[16:19], a[80:83], v[148:151], a[16:19]
  v_mfma_f32_16x16x32_bf16 a[32:35], a[80:83], v[152:155], a[32:35]
  v_mfma_f32_16x16x32_bf16 a[48:51], a[80:83], v[156:159], a[48:51]
  buffer_load_dwordx4 v[244:247], v26, s[64:67], s14 offen sc1
  ds_read_b64_tr_b16 a[80:81], v21 offset:24576
  ds_read_b64_tr_b16 a[82:83], v21 offset:26624
  v_mfma_f32_16x16x32_bf16 a[4:7], a[84:87], v[144:147], a[4:7]
  v_mfma_f32_16x16x32_bf16 a[20:23], a[84:87], v[148:151], a[20:23]
  v_mfma_f32_16x16x32_bf16 a[36:39], a[84:87], v[152:155], a[36:39]
  s_add_u32 s14, s97, 2048
  buffer_load_dwordx4 v[248:251], v25, s[64:67], s14 offen sc1
  v_mfma_f32_16x16x32_bf16 a[52:55], a[84:87], v[156:159], a[52:55]
  ds_read_b64_tr_b16 a[84:85], v22 offset:24576
  ds_read_b64_tr_b16 a[86:87], v22 offset:26624
  v_mfma_f32_16x16x32_bf16 a[8:11], a[88:91], v[144:147], a[8:11]
  v_mfma_f32_16x16x32_bf16 a[24:27], a[88:91], v[148:151], a[24:27]
  buffer_load_dwordx4 v[252:255], v26, s[64:67], s14 offen sc1
  v_mfma_f32_16x16x32_bf16 a[40:43], a[88:91], v[152:155], a[40:43]
  v_mfma_f32_16x16x32_bf16 a[56:59], a[88:91], v[156:159], a[56:59]
  ds_read_b64_tr_b16 a[88:89], v23 offset:24576
  ds_read_b64_tr_b16 a[90:91], v23 offset:26624
  v_mfma_f32_16x16x32_bf16 a[12:15], a[92:95], v[144:147], a[12:15]
  v_mfma_f32_16x16x32_bf16 a[28:31], a[92:95], v[148:151], a[28:31]
  v_mfma_f32_16x16x32_bf16 a[44:47], a[92:95], v[152:155], a[44:47]
  v_mfma_f32_16x16x32_bf16 a[60:63], a[92:95], v[156:159], a[60:63]
  ds_read_b64_tr_b16 a[92:93], v24 offset:24576
  ds_read_b64_tr_b16 a[94:95], v24 offset:26624
  v_mfma_f32_16x16x32_bf16 a[0:3], a[96:99], v[160:163], a[0:3]
  s_add_u32 s14, s96, 11520
  buffer_load_dwordx4 v[128:131], v25, s[64:67], s14 offen sc1
  s_waitcnt vmcnt(26)
  ds_read_b64 v[64:65], v4 offset:8192
  ds_read_b64 v[72:73], v5 offset:10240
  ds_read_b64 v[80:81], v5 offset:10496
  v_mfma_f32_16x16x32_bf16 a[16:19], a[96:99], v[164:167], a[16:19]
  v_mfma_f32_16x16x32_bf16 a[32:35], a[96:99], v[168:171], a[32:35]
  v_mfma_f32_16x16x32_bf16 a[48:51], a[96:99], v[172:175], a[48:51]
  buffer_load_dwordx4 v[132:135], v26, s[64:67], s14 offen sc1
  ds_read_b64 v[66:67], v4 offset:8224
  ds_read_b64 v[74:75], v5 offset:10272
  ds_read_b64 v[82:83], v5 offset:10528
  v_mfma_f32_16x16x32_bf16 a[4:7], a[100:103], v[160:163], a[4:7]
  v_mfma_f32_16x16x32_bf16 a[20:23], a[100:103], v[164:167], a[20:23]
  v_mfma_f32_16x16x32_bf16 a[36:39], a[100:103], v[168:171], a[36:39]
  v_mfma_f32_16x16x32_bf16 a[52:55], a[100:103], v[172:175], a[52:55]
  s_add_u32 s14, s97, 11520
  buffer_load_dwordx4 v[136:139], v25, s[64:67], s14 offen sc1
  ds_read_b64 v[68:69], v4 offset:8256
  ds_read_b64 v[76:77], v5 offset:10304
  ds_read_b64 v[84:85], v5 offset:10560
  v_mfma_f32_16x16x32_bf16 a[8:11], a[104:107], v[160:163], a[8:11]
  v_mfma_f32_16x16x32_bf16 a[24:27], a[104:107], v[164:167], a[24:27]
  v_mfma_f32_16x16x32_bf16 a[40:43], a[104:107], v[168:171], a[40:43]
  buffer_load_dwordx4 v[140:143], v26, s[64:67], s14 offen sc1
  ds_read_b64 v[70:71], v4 offset:8288
  ds_read_b64 v[78:79], v5 offset:10336
  ds_read_b64 v[86:87], v5 offset:10592
  v_mfma_f32_16x16x32_bf16 a[56:59], a[104:107], v[172:175], a[56:59]
  v_mfma_f32_16x16x32_bf16 a[12:15], a[108:111], v[160:163], a[12:15]
  v_mfma_f32_16x16x32_bf16 a[28:31], a[108:111], v[164:167], a[28:31]
  v_mfma_f32_16x16x32_bf16 a[44:47], a[108:111], v[168:171], a[44:47]
  v_mfma_f32_16x16x32_bf16 a[60:63], a[108:111], v[172:175], a[60:63]
  s_waitcnt lgkmcnt(15)
  v_mfma_f32_16x16x32_bf16 a[0:3], a[112:115], v[176:179], a[0:3]
  s_add_u32 s14, s96, 13568
  buffer_load_dwordx4 v[144:147], v25, s[64:67], s14 offen sc1
  v_mfma_f32_16x16x32_bf16 a[16:19], a[112:115], v[180:183], a[16:19]
  v_mfma_f32_16x16x32_bf16 a[32:35], a[112:115], v[184:187], a[32:35]
  v_mfma_f32_16x16x32_bf16 a[48:51], a[112:115], v[188:191], a[48:51]
  buffer_load_dwordx4 v[148:151], v26, s[64:67], s14 offen sc1
  v_mfma_f32_16x16x32_bf16 a[4:7], a[116:119], v[176:179], a[4:7]
  v_mfma_f32_16x16x32_bf16 a[20:23], a[116:119], v[180:183], a[20:23]
  v_mfma_f32_16x16x32_bf16 a[36:39], a[116:119], v[184:187], a[36:39]
  v_mfma_f32_16x16x32_bf16 a[52:55], a[116:119], v[188:191], a[52:55]
  s_add_u32 s14, s97, 13568
  buffer_load_dwordx4 v[152:155], v25, s[64:67], s14 offen sc1
  v_mfma_f32_16x16x32_bf16 a[8:11], a[120:123], v[176:179], a[8:11]
  v_mfma_f32_16x16x32_bf16 a[24:27], a[120:123], v[180:183], a[24:27]
  v_mfma_f32_16x16x32_bf16 a[40:43], a[120:123], v[184:187], a[40:43]
  buffer_load_dwordx4 v[156:159], v26, s[64:67], s14 offen sc1
  v_mfma_f32_16x16x32_bf16 a[56:59], a[120:123], v[188:191], a[56:59]
  v_mfma_f32_16x16x32_bf16 a[12:15], a[124:127], v[176:179], a[12:15]
  v_mfma_f32_16x16x32_bf16 a[28:31], a[124:127], v[180:183], a[28:31]
  v_mfma_f32_16x16x32_bf16 a[44:47], a[124:127], v[184:187], a[44:47]
  v_mfma_f32_16x16x32_bf16 a[60:63], a[124:127], v[188:191], a[60:63]
  s_waitcnt vmcnt(25)
  v_mfma_f32_16x16x32_bf16 a[0:3], a[64:67], v[192:195], a[0:3]
  s_add_u32 s14, s96, 23040
  buffer_load_dwordx4 v[160:163], v25, s[64:67], s14 offen sc1
  v_mfma_f32_16x16x32_bf16 a[16:19], a[64:67], v[196:199], a[16:19]
  v_xor_b32 v53, v2, v3
  v_lshlrev_b32 v53, 4, v53
  v_lshl_add_u32 v44, v3, 8, v53
  v_mfma_f32_16x16x32_bf16 a[32:35], a[64:67], v[200:203], a[32:35]
  v_lshl_add_u32 v112, v2, 8, v53
  v_add_u32 v44, s8, v44
  v_add_u32 v112, s8, v112
  v_mfma_f32_16x16x32_bf16 a[48:51], a[64:67], v[204:207], a[48:51]
  v_xor_b32 v45, 64, v44
  v_xor_b32 v113, 64, v112
  v_xor_b32 v46, 128, v44
  v_mfma_f32_16x16x32_bf16 a[4:7], a[68:71], v[192:195], a[4:7]
  buffer_load_dwordx4 v[164:167], v26, s[64:67], s14 offen sc1
  v_mfma_f32_16x16x32_bf16 a[20:23], a[68:71], v[196:199], a[20:23]
  v_xor_b32 v114, 128, v112
  v_xor_b32 v47, 192, v44
  v_xor_b32 v115, 192, v112
  v_mfma_f32_16x16x32_bf16 a[36:39], a[68:71], v[200:203], a[36:39]
  v_xor_b32 v116, 32768, v112
  v_xor_b32 v117, 32768, v113
  v_xor_b32 v118, 32768, v114
  v_mfma_f32_16x16x32_bf16 a[52:55], a[68:71], v[204:207], a[52:55]
  v_xor_b32 v119, 32768, v115
  v_xor_b32 v120, 65536, v112
  v_xor_b32 v121, 65536, v113
  s_add_u32 s14, s97, 23040
  buffer_load_dwordx4 v[168:171], v25, s[64:67], s14 offen sc1
  v_mfma_f32_16x16x32_bf16 a[8:11], a[72:75], v[192:195], a[8:11]
  v_xor_b32 v122, 65536, v114
  v_xor_b32 v123, 65536, v115
  v_xor_b32 v124, 98304, v112
  v_mfma_f32_16x16x32_bf16 a[24:27], a[72:75], v[196:199], a[24:27]
  v_xor_b32 v125, 98304, v113
  v_xor_b32 v126, 98304, v114
  v_xor_b32 v127, 98304, v115
  v_mfma_f32_16x16x32_bf16 a[40:43], a[72:75], v[200:203], a[40:43]
  s_waitcnt vmcnt(27)
  s_waitcnt lgkmcnt(0)
  v_mfma_f32_16x16x32_bf16 a[56:59], a[72:75], v[204:207], a[56:59]
  buffer_load_dwordx4 v[172:175], v26, s[64:67], s14 offen sc1
  v_mfma_f32_16x16x32_bf16 a[12:15], a[76:79], v[192:195], a[12:15]
  v_lshlrev_b32 v40, 1, v40
  v_lshlrev_b32 v4, 16, v64
  v_mfma_f32_16x16x32_bf16 a[28:31], a[76:79], v[196:199], a[28:31]
  v_and_b32 v5, 0xffff0000, v64
  v_lshlrev_b32 v6, 16, v65
  v_mfma_f32_16x16x32_bf16 a[44:47], a[76:79], v[200:203], a[44:47]
  v_and_b32 v7, 0xffff0000, v65
  v_lshlrev_b32 v8, 16, v72
  v_mfma_f32_16x16x32_bf16 a[60:63], a[76:79], v[204:207], a[60:63]
  s_waitcnt vmcnt(20)
  v_mfma_f32_16x16x32_bf16 a[0:3], a[80:83], v[208:211], a[0:3]
  s_add_u32 s14, s96, 25088
  buffer_load_dwordx4 v[176:179], v25, s[64:67], s14 offen sc1
  v_mfma_f32_16x16x32_bf16 a[16:19], a[80:83], v[212:215], a[16:19]
  v_and_b32 v9, 0xffff0000, v72
  v_lshlrev_b32 v10, 16, v73
  v_mfma_f32_16x16x32_bf16 a[32:35], a[80:83], v[216:219], a[32:35]
  v_and_b32 v11, 0xffff0000, v73
  v_lshlrev_b32 v12, 16, v80
  v_mfma_f32_16x16x32_bf16 a[48:51], a[80:83], v[220:223], a[48:51]
  v_and_b32 v13, 0xffff0000, v80
  v_lshlrev_b32 v14, 16, v81
  v_mfma_f32_16x16x32_bf16 a[4:7], a[84:87], v[208:211], a[4:7]
  buffer_load_dwordx4 v[180:183], v26, s[64:67], s14 offen sc1
  v_mfma_f32_16x16x32_bf16 a[20:23], a[84:87], v[212:215], a[20:23]
  v_and_b32 v15, 0xffff0000, v81
  v_add_f32 v96, v4, v12
  v_mfma_f32_16x16x32_bf16 a[36:39], a[84:87], v[216:219], a[36:39]
  v_sub_f32 v4, v4, v88
  v_add_f32 v97, v5, v13
  v_mfma_f32_16x16x32_bf16 a[52:55], a[84:87], v[220:223], a[52:55]
  v_sub_f32 v5, v5, v88
  v_add_f32 v98, v6, v14
  s_add_u32 s14, s97, 25088
  buffer_load_dwordx4 v[184:187], v25, s[64:67], s14 offen sc1
  v_mfma_f32_16x16x32_bf16 a[8:11], a[88:91], v[208:211], a[8:11]
  v_sub_f32 v6, v6, v88
  v_add_f32 v99, v7, v15
  v_mfma_f32_16x16x32_bf16 a[24:27], a[88:91], v[212:215], a[24:27]
  v_sub_f32 v7, v7, v88
  v_cvt_pk_bf16_f32 v4, v4, v4
  v_mfma_f32_16x16x32_bf16 a[40:43], a[88:91], v[216:219], a[40:43]
  v_and_b32 v4, 0xffff0000, v4
  v_cvt_pk_bf16_f32 v5, v5, v5
  v_mfma_f32_16x16x32_bf16 a[56:59], a[88:91], v[220:223], a[56:59]
  buffer_load_dwordx4 v[188:191], v26, s[64:67], s14 offen sc1
  v_mfma_f32_16x16x32_bf16 a[12:15], a[92:95], v[208:211], a[12:15]
  v_and_b32 v5, 0xffff0000, v5
  v_cvt_pk_bf16_f32 v6, v6, v6
  v_mfma_f32_16x16x32_bf16 a[28:31], a[92:95], v[212:215], a[28:31]
  v_and_b32 v6, 0xffff0000, v6
  v_cvt_pk_bf16_f32 v7, v7, v7
  s_waitcnt vmcnt(16)
  s_mov_b32 s51, 0
Lc14:
  v_max3_u32 v52, v224, v228, v232
  v_max3_u32 v53, v236, v240, v244
  v_max3_u32 v52, v52, v248, v252
  v_max_u32 v52, v52, v53
  v_cmp_eq_u32 vcc, -1, v52
  s_cbranch_vccz Lc14ok
  s_add_u32 s50, s96, 0
  buffer_load_dwordx4 v[224:227], v25, s[64:67], s50 offen sc1
  buffer_load_dwordx4 v[228:231], v26, s[64:67], s50 offen sc1
  s_add_u32 s50, s97, 0
  buffer_load_dwordx4 v[232:235], v25, s[64:67], s50 offen sc1
  buffer_load_dwordx4 v[236:239], v26, s[64:67], s50 offen sc1
  s_add_u32 s50, s96, 2048
  buffer_load_dwordx4 v[240:243], v25, s[64:67], s50 offen sc1
  buffer_load_dwordx4 v[244:247], v26, s[64:67], s50 offen sc1
  s_add_u32 s50, s97, 2048
  buffer_load_dwordx4 v[248:251], v25, s[64:67], s50 offen sc1
  buffer_load_dwordx4 v[252:255], v26, s[64:67], s50 offen sc1
  s_add_u32 s50, s96, 11520
  buffer_load_dwordx4 v[128:131], v25, s[64:67], s50 offen sc1
  buffer_load_dwordx4 v[132:135], v26, s[64:67], s50 offen sc1
  s_add_u32 s50, s97, 11520
  buffer_load_dwordx4 v[136:139], v25, s[64:67], s50 offen sc1
  buffer_load_dwordx4 v[140:143], v26, s[64:67], s50 offen sc1
  s_add_u32 s50, s96, 13568
  buffer_load_dwordx4 v[144:147], v25, s[64:67], s50 offen sc1
  buffer_load_dwordx4 v[148:151], v26, s[64:67], s50 offen sc1
  s_add_u32 s50, s97, 13568
  buffer_load_dwordx4 v[152:155], v25, s[64:67], s50 offen sc1
  buffer_load_dwordx4 v[156:159], v26, s[64:67], s50 offen sc1
  s_add_u32 s50, s96, 23040
  buffer_load_dwordx4 v[160:163], v25, s[64:67], s50 offen sc1
  buffer_load_dwordx4 v[164:167], v26, s[64:67], s50 offen sc1
  s_add_u32 s50, s97, 23040
  buffer_load_dwordx4 v[168:171], v25, s[64:67], s50 offen sc1
  buffer_load_dwordx4 v[172:175], v26, s[64:67], s50 offen sc1
  s_add_u32 s50, s96, 25088
  buffer_load_dwordx4 v[176:179], v25, s[64:67], s50 offen sc1
  buffer_load_dwordx4 v[180:183], v26, s[64:67], s50 offen sc1
  s_add_u32 s50, s97, 25088
  buffer_load_dwordx4 v[184:187], v25, s[64:67], s50 offen sc1
  buffer_load_dwordx4 v[188:191], v26, s[64:67], s50 offen sc1
  s_add_u32 s51, s51, 1
  s_waitcnt vmcnt(0)
  s_cmp_lt_u32 s51, 0x40000
  s_cbranch_scc1 Lc14
Lc14ok:
  v_mfma_f32_16x16x32_bf16 a[44:47], a[92:95], v[216:219], a[44:47]
  v_and_b32 v7, 0xffff0000, v7
  v_mul_f32 v4, v4, v89
  v_mfma_f32_16x16x32_bf16 a[60:63], a[92:95], v[220:223], a[60:63]
  v_mfma_f32_16x16x32_bf16 a[0:3], a[128:131], v[224:227], a[0:3]
  s_add_u32 s14, s96, 34560
  buffer_load_dwordx4 v[192:195], v25, s[64:67], s14 offen sc1
  v_mfma_f32_16x16x32_bf16 a[16:19], a[128:131], v[228:231], a[16:19]
  v_mul_f32 v5, v5, v89
  v_mul_f32 v6, v6, v89
  v_mfma_f32_16x16x32_bf16 a[32:35], a[128:131], v[232:235], a[32:35]
  v_mul_f32 v7, v7, v89
  v_cvt_pk_bf16_f32 v4, v4, v4
  v_mfma_f32_16x16x32_bf16 a[48:51], a[128:131], v[236:239], a[48:51]
  v_and_b32 v4, 0xffff0000, v4
  v_cvt_pk_bf16_f32 v5, v5, v5
  v_mfma_f32_16x16x32_bf16 a[4:7], a[132:135], v[224:227], a[4:7]
  buffer_load_dwordx4 v[196:199], v26, s[64:67], s14 offen sc1
  v_mfma_f32_16x16x32_bf16 a[20:23], a[132:135], v[228:231], a[20:23]
  v_and_b32 v5, 0xffff0000, v5
  v_cvt_pk_bf16_f32 v6, v6, v6
  v_mfma_f32_16x16x32_bf16 a[36:39], a[132:135], v[232:235], a[36:39]
  v_and_b32 v6, 0xffff0000, v6
  v_cvt_pk_bf16_f32 v7, v7, v7
  v_mfma_f32_16x16x32_bf16 a[52:55], a[132:135], v[236:239], a[52:55]
  v_and_b32 v7, 0xffff0000, v7
  v_mul_f32 v4, v4, v8
  v_mfma_f32_16x16x32_bf16 a[8:11], a[136:139], v[224:227], a[8:11]
  s_add_u32 s14, s97, 34560
  buffer_load_dwordx4 v[200:203], v25, s[64:67], s14 offen sc1
  v_mfma_f32_16x16x32_bf16 a[24:27], a[136:139], v[228:231], a[24:27]
  v_mul_f32 v5, v5, v9
  v_mul_f32 v6, v6, v10
  v_mfma_f32_16x16x32_bf16 a[40:43], a[136:139], v[232:235], a[40:43]
  v_mul_f32 v7, v7, v11
  v_cvt_pk_bf16_f32 v4, v4, v4
  v_mfma_f32_16x16x32_bf16 a[56:59], a[136:139], v[236:239], a[56:59]
  v_and_b32 v4, 0xffff0000, v4
  v_cvt_pk_bf16_f32 v5, v5, v5
  v_mfma_f32_16x16x32_bf16 a[12:15], a[140:143], v[224:227], a[12:15]
  buffer_load_dwordx4 v[204:207], v26, s[64:67], s14 offen sc1
  v_mfma_f32_16x16x32_bf16 a[28:31], a[140:143], v[228:231], a[28:31]
  v_and_b32 v5, 0xffff0000, v5
  v_cvt_pk_bf16_f32 v6, v6, v6
  v_mfma_f32_16x16x32_bf16 a[44:47], a[140:143], v[232:235], a[44:47]
  v_and_b32 v6, 0xffff0000, v6
  v_cvt_pk_bf16_f32 v7, v7, v7
  v_mfma_f32_16x16x32_bf16 a[60:63], a[140:143], v[236:239], a[60:63]
  v_and_b32 v7, 0xffff0000, v7
  v_add_f32 v96, v96, v4
  v_mfma_f32_16x16x32_bf16 a[0:3], a[144:147], v[240:243], a[0:3]
  s_add_u32 s14, s96, 36608
  buffer_load_dwordx4 v[208:211], v25, s[64:67], s14 offen sc1
  v_mfma_f32_16x16x32_bf16 a[16:19], a[144:147], v[244:247], a[16:19]
  v_add_f32 v97, v97, v5
  v_add_f32 v98, v98, v6
  v_mfma_f32_16x16x32_bf16 a[32:35], a[144:147], v[248:251], a[32:35]
  v_add_f32 v99, v99, v7
  v_lshlrev_b32 v4, 16, v66
  v_mfma_f32_16x16x32_bf16 a[48:51], a[144:147], v[252:255], a[48:51]
  v_and_b32 v5, 0xffff0000, v66
  v_lshlrev_b32 v6, 16, v67
  v_mfma_f32_16x16x32_bf16 a[4:7], a[148:151], v[240:243], a[4:7]
  buffer_load_dwordx4 v[212:215], v26, s[64:67], s14 offen sc1
  v_mfma_f32_16x16x32_bf16 a[20:23], a[148:151], v[244:247], a[20:23]
  v_and_b32 v7, 0xffff0000, v67
  v_lshlrev_b32 v8, 16, v74
  v_mfma_f32_16x16x32_bf16 a[36:39], a[148:151], v[248:251], a[36:39]
  v_and_b32 v9, 0xffff0000, v74
  v_lshlrev_b32 v10, 16, v75
  v_mfma_f32_16x16x32_bf16 a[52:55], a[148:151], v[252:255], a[52:55]
  v_and_b32 v11, 0xffff0000, v75
  v_lshlrev_b32 v12, 16, v82
  v_mfma_f32_16x16x32_bf16 a[8:11], a[152:155], v[240:243], a[8:11]
  s_add_u32 s14, s97, 36608
  buffer_load_dwordx4 v[216:219], v25, s[64:67], s14 offen sc1
  v_mfma_f32_16x16x32_bf16 a[24:27], a[152:155], v[244:247], a[24:27]
  v_and_b32 v13, 0xffff0000, v82
  v_lshlrev_b32 v14, 16, v83
  v_mfma_f32_16x16x32_bf16 a[40:43], a[152:155], v[248:251], a[40:43]
  v_and_b32 v15, 0xffff0000, v83
  v_add_f32 v100, v4, v12
  v_mfma_f32_16x16x32_bf16 a[56:59], a[152:155], v[252:255], a[56:59]
  v_sub_f32 v4, v4, v88
  v_add_f32 v101, v5, v13
  v_mfma_f32_16x16x32_bf16 a[12:15], a[156:159], v[240:243], a[12:15]
  buffer_load_dwordx4 v[220:223], v26, s[64:67], s14 offen sc1
  v_mfma_f32_16x16x32_bf16 a[28:31], a[156:159], v[244:247], a[28:31]
  v_sub_f32 v5, v5, v88
  v_add_f32 v102, v6, v14
  s_waitcnt vmcnt(16)
  s_mov_b32 s51, 0
Lc16:
  v_max3_u32 v52, v128, v132, v136
  v_max3_u32 v53, v140, v144, v148
  v_max3_u32 v52, v52, v152, v156
  v_max_u32 v52, v52, v53
  v_cmp_eq_u32 vcc, -1, v52
  s_cbranch_vccz Lc16ok
  s_add_u32 s50, s96, 11520
  buffer_load_dwordx4 v[128:131], v25, s[64:67], s50 offen sc1
  buffer_load_dwordx4 v[132:135], v26, s[64:67], s50 offen sc1
  s_add_u32 s50, s97, 11520
  buffer_load_dwordx4 v[136:139], v25, s[64:67], s50 offen sc1
  buffer_load_dwordx4 v[140:143], v26, s[64:67], s50 offen sc1
  s_add_u32 s50, s96, 13568
  buffer_load_dwordx4 v[144:147], v25, s[64:67], s50 offen sc1
  buffer_load_dwordx4 v[148:151], v26, s[64:67], s50 offen sc1
  s_add_u32 s50, s97, 13568
  buffer_load_dwordx4 v[152:155], v25, s[64:67], s50 offen sc1
  buffer_load_dwordx4 v[156:159], v26, s[64:67], s50 offen sc1
  s_add_u32 s50, s96, 23040
  buffer_load_dwordx4 v[160:163], v25, s[64:67], s50 offen sc1
  buffer_load_dwordx4 v[164:167], v26, s[64:67], s50 offen sc1
  s_add_u32 s50, s97, 23040
  buffer_load_dwordx4 v[168:171], v25, s[64:67], s50 offen sc1
  buffer_load_dwordx4 v[172:175], v26, s[64:67], s50 offen sc1
  s_add_u32 s50, s96, 25088
  buffer_load_dwordx4 v[176:179], v25, s[64:67], s50 offen sc1
  buffer_load_dwordx4 v[180:183], v26, s[64:67], s50 offen sc1
  s_add_u32 s50, s97, 25088
  buffer_load_dwordx4 v[184:187], v25, s[64:67], s50 offen sc1
  buffer_load_dwordx4 v[188:191], v26, s[64:67], s50 offen sc1
  s_add_u32 s50, s96, 34560
  buffer_load_dwordx4 v[192:195], v25, s[64:67], s50 offen sc1
  buffer_load_dwordx4 v[196:199], v26, s[64:67], s50 offen sc1
  s_add_u32 s50, s97, 34560
  buffer_load_dwordx4 v[200:203], v25, s[64:67], s50 offen sc1
  buffer_load_dwordx4 v[204:207], v26, s[64:67], s50 offen sc1
  s_add_u32 s50, s96, 36608
  buffer_load_dwordx4 v[208:211], v25, s[64:67], s50 offen sc1
  buffer_load_dwordx4 v[212:215], v26, s[64:67], s50 offen sc1
  s_add_u32 s50, s97, 36608
  buffer_load_dwordx4 v[216:219], v25, s[64:67], s50 offen sc1
  buffer_load_dwordx4 v[220:223], v26, s[64:67], s50 offen sc1
  s_add_u32 s51, s51, 1
  s_waitcnt vmcnt(0)
  s_cmp_lt_u32 s51, 0x40000
  s_cbranch_scc1 Lc16
Lc16ok:
  v_mfma_f32_16x16x32_bf16 a[44:47], a[156:159], v[248:251], a[44:47]
  v_sub_f32 v6, v6, v88
  v_add_f32 v103, v7, v15
  v_mfma_f32_16x16x32_bf16 a[60:63], a[156:159], v[252:255], a[60:63]
  v_sub_f32 v7, v7, v88
  v_cvt_pk_bf16_f32 v4, v4, v4
  v_mfma_f32_16x16x32_bf16 a[0:3], a[160:163], v[128:131], a[0:3]
  v_and_b32 v4, 0xffff0000, v4
  v_cvt_pk_bf16_f32 v5, v5, v5
  v_mfma_f32_16x16x32_bf16 a[16:19], a[160:163], v[132:135], a[16:19]
  v_and_b32 v5, 0xffff0000, v5
  v_cvt_pk_bf16_f32 v6, v6, v6
  v_mfma_f32_16x16x32_bf16 a[32:35], a[160:163], v[136:139], a[32:35]
  v_and_b32 v6, 0xffff0000, v6
  v_cvt_pk_bf16_f32 v7, v7, v7
  v_mfma_f32_16x16x32_bf16 a[48:51], a[160:163], v[140:143], a[48:51]
  v_and_b32 v7, 0xffff0000, v7
  v_mul_f32 v4, v4, v89
  v_mfma_f32_16x16x32_bf16 a[4:7], a[164:167], v[128:131], a[4:7]
  v_mul_f32 v5, v5, v89
  v_mul_f32 v6, v6, v89
  v_mfma_f32_16x16x32_bf16 a[20:23], a[164:167], v[132:135], a[20:23]
  v_mul_f32 v7, v7, v89
  v_cvt_pk_bf16_f32 v4, v4, v4
  v_mfma_f32_16x16x32_bf16 a[36:39], a[164:167], v[136:139], a[36:39]
  v_and_b32 v4, 0xffff0000, v4
  v_cvt_pk_bf16_f32 v5, v5, v5
  v_mfma_f32_16x16x32_bf16 a[52:55], a[164:167], v[140:143], a[52:55]
  v_and_b32 v5, 0xffff0000, v5
  v_cvt_pk_bf16_f32 v6, v6, v6
  v_mfma_f32_16x16x32_bf16 a[8:11], a[168:171], v[128:131], a[8:11]
  v_and_b32 v6, 0xffff0000, v6
  v_cvt_pk_bf16_f32 v7, v7, v7
  v_mfma_f32_16x16x32_bf16 a[24:27], a[168:171], v[132:135], a[24:27]
  v_and_b32 v7, 0xffff0000, v7
  v_mul_f32 v4, v4, v8
  v_mfma_f32_16x16x32_bf16 a[40:43], a[168:171], v[136:139], a[40:43]
  v_mul_f32 v5, v5, v9
  v_mul_f32 v6, v6, v10
  v_mfma_f32_16x16x32_bf16 a[56:59], a[168:171], v[140:143], a[56:59]
  v_mul_f32 v7, v7, v11
  v_cvt_pk_bf16_f32 v4, v4, v4
  v_mfma_f32_16x16x32_bf16 a[12:15], a[172:175], v[128:131], a[12:15]
  v_and_b32 v4, 0xffff0000, v4
  v_cvt_pk_bf16_f32 v5, v5, v5
  v_mfma_f32_16x16x32_bf16 a[28:31], a[172:175], v[132:135], a[28:31]
  v_and_b32 v5, 0xffff0000, v5
  v_cvt_pk_bf16_f32 v6, v6, v6
  v_mfma_f32_16x16x32_bf16 a[44:47], a[172:175], v[136:139], a[44:47]
  v_and_b32 v6, 0xffff0000, v6
  v_cvt_pk_bf16_f32 v7, v7, v7
  v_mfma_f32_16x16x32_bf16 a[60:63], a[172:175], v[140:143], a[60:63]
  v_and_b32 v7, 0xffff0000, v7
  v_add_f32 v100, v100, v4
  v_mfma_f32_16x16x32_bf16 a[0:3], a[176:179], v[144:147], a[0:3]
  v_add_f32 v101, v101, v5
  v_add_f32 v102, v102, v6
  v_mfma_f32_16x16x32_bf16 a[16:19], a[176:179], v[148:151], a[16:19]
  v_add_f32 v103, v103, v7
  v_lshlrev_b32 v4, 16, v68
  v_mfma_f32_16x16x32_bf16 a[32:35], a[176:179], v[152:155], a[32:35]
  v_and_b32 v5, 0xffff0000, v68
  v_lshlrev_b32 v6, 16, v69
  v_mfma_f32_16x16x32_bf16 a[48:51], a[176:179], v[156:159], a[48:51]
  v_and_b32 v7, 0xffff0000, v69
  v_lshlrev_b32 v8, 16, v76
  v_mfma_f32_16x16x32_bf16 a[4:7], a[180:183], v[144:147], a[4:7]
  v_and_b32 v9, 0xffff0000, v76
  v_lshlrev_b32 v10, 16, v77
  v_mfma_f32_16x16x32_bf16 a[20:23], a[180:183], v[148:151], a[20:23]
  v_and_b32 v11, 0xffff0000, v77
  v_lshlrev_b32 v12, 16, v84
  v_mfma_f32_16x16x32_bf16 a[36:39], a[180:183], v[152:155], a[36:39]
  v_and_b32 v13, 0xffff0000, v84
  v_lshlrev_b32 v14, 16, v85
  v_mfma_f32_16x16x32_bf16 a[52:55], a[180:183], v[156:159], a[52:55]
  v_and_b32 v15, 0xffff0000, v85
  v_add_f32 v104, v4, v12
  v_mfma_f32_16x16x32_bf16 a[8:11], a[184:187], v[144:147], a[8:11]
  v_sub_f32 v4, v4, v88
  v_add_f32 v105, v5, v13
  v_mfma_f32_16x16x32_bf16 a[24:27], a[184:187], v[148:151], a[24:27]
  v_sub_f32 v5, v5, v88
  v_add_f32 v106, v6, v14
  v_mfma_f32_16x16x32_bf16 a[40:43], a[184:187], v[152:155], a[40:43]
  v_sub_f32 v6, v6, v88
  v_add_f32 v107, v7, v15
  v_mfma_f32_16x16x32_bf16 a[56:59], a[184:187], v[156:159], a[56:59]
  v_sub_f32 v7, v7, v88
  v_cvt_pk_bf16_f32 v4, v4, v4
  v_mfma_f32_16x16x32_bf16 a[12:15], a[188:191], v[144:147], a[12:15]
  v_and_b32 v4, 0xffff0000, v4
  v_cvt_pk_bf16_f32 v5, v5, v5
  v_mfma_f32_16x16x32_bf16 a[28:31], a[188:191], v[148:151], a[28:31]
  v_and_b32 v5, 0xffff0000, v5
  v_cvt_pk_bf16_f32 v6, v6, v6
  s_waitcnt vmcnt(8)
  s_mov_b32 s51, 0
Lc18:
  v_max3_u32 v52, v160, v164, v168
  v_max3_u32 v53, v172, v176, v180
  v_max3_u32 v52, v52, v184, v188
  v_max_u32 v52, v52, v53
  v_cmp_eq_u32 vcc, -1, v52
  s_cbranch_vccz Lc18ok
  s_add_u32 s50, s96, 23040
  buffer_load_dwordx4 v[160:163], v25, s[64:67], s50 offen sc1
  buffer_load_dwordx4 v[164:167], v26, s[64:67], s50 offen sc1
  s_add_u32 s50, s97, 23040
  buffer_load_dwordx4 v[168:171], v25, s[64:67], s50 offen sc1
  buffer_load_dwordx4 v[172:175], v26, s[64:67], s50 offen sc1
  s_add_u32 s50, s96, 25088
  buffer_load_dwordx4 v[176:179], v25, s[64:67], s50 offen sc1
  buffer_load_dwordx4 v[180:183], v26, s[64:67], s50 offen sc1
  s_add_u32 s50, s97, 25088
  buffer_load_dwordx4 v[184:187], v25, s[64:67], s50 offen sc1
  buffer_load_dwordx4 v[188:191], v26, s[64:67], s50 offen sc1
  s_add_u32 s50, s96, 34560
  buffer_load_dwordx4 v[192:195], v25, s[64:67], s50 offen sc1
  buffer_load_dwordx4 v[196:199], v26, s[64:67], s50 offen sc1
  s_add_u32 s50, s97, 34560
  buffer_load_dwordx4 v[200:203], v25, s[64:67], s50 offen sc1
  buffer_load_dwordx4 v[204:207], v26, s[64:67], s50 offen sc1
  s_add_u32 s50, s96, 36608
  buffer_load_dwordx4 v[208:211], v25, s[64:67], s50 offen sc1
  buffer_load_dwordx4 v[212:215], v26, s[64:67], s50 offen sc1
  s_add_u32 s50, s97, 36608
  buffer_load_dwordx4 v[216:219], v25, s[64:67], s50 offen sc1
  buffer_load_dwordx4 v[220:223], v26, s[64:67], s50 offen sc1
  s_add_u32 s51, s51, 1
  s_waitcnt vmcnt(0)
  s_cmp_lt_u32 s51, 0x40000
  s_cbranch_scc1 Lc18
Lc18ok:
  v_mfma_f32_16x16x32_bf16 a[44:47], a[188:191], v[152:155], a[44:47]
  v_and_b32 v6, 0xffff0000, v6
  v_cvt_pk_bf16_f32 v7, v7, v7
  v_mfma_f32_16x16x32_bf16 a[60:63], a[188:191], v[156:159], a[60:63]
  v_and_b32 v7, 0xffff0000, v7
  v_mul_f32 v4, v4, v89
  v_mfma_f32_16x16x32_bf16 a[0:3], a[192:195], v[160:163], a[0:3]
  v_mul_f32 v5, v5, v89
  v_mul_f32 v6, v6, v89
  v_mfma_f32_16x16x32_bf16 a[16:19], a[192:195], v[164:167], a[16:19]
  v_mul_f32 v7, v7, v89
  v_cvt_pk_bf16_f32 v4, v4, v4
  v_mfma_f32_16x16x32_bf16 a[32:35], a[192:195], v[168:171], a[32:35]
  v_and_b32 v4, 0xffff0000, v4
  v_cvt_pk_bf16_f32 v5, v5, v5
  v_mfma_f32_16x16x32_bf16 a[48:51], a[192:195], v[172:175], a[48:51]
  v_and_b32 v5, 0xffff0000, v5
  v_cvt_pk_bf16_f32 v6, v6, v6
  v_mfma_f32_16x16x32_bf16 a[4:7], a[196:199], v[160:163], a[4:7]
  v_and_b32 v6, 0xffff0000, v6
  v_cvt_pk_bf16_f32 v7, v7, v7
  v_mfma_f32_16x16x32_bf16 a[20:23], a[196:199], v[164:167], a[20:23]
  v_and_b32 v7, 0xffff0000, v7
  v_mul_f32 v4, v4, v8
  v_mfma_f32_16x16x32_bf16 a[36:39], a[196:199], v[168:171], a[36:39]
  v_mul_f32 v5, v5, v9
  v_mul_f32 v6, v6, v10
  v_mfma_f32_16x16x32_bf16 a[52:55], a[196:199], v[172:175], a[52:55]
  v_mul_f32 v7, v7, v11
  v_cvt_pk_bf16_f32 v4, v4, v4
  v_mfma_f32_16x16x32_bf16 a[8:11], a[200:203], v[160:163], a[8:11]
  v_and_b32 v4, 0xffff0000, v4
  v_cvt_pk_bf16_f32 v5, v5, v5
  v_mfma_f32_16x16x32_bf16 a[24:27], a[200:203], v[164:167], a[24:27]
  v_and_b32 v5, 0xffff0000, v5
  v_cvt_pk_bf16_f32 v6, v6, v6
  v_mfma_f32_16x16x32_bf16 a[40:43], a[200:203], v[168:171], a[40:43]
  v_and_b32 v6, 0xffff0000, v6
  v_cvt_pk_bf16_f32 v7, v7, v7
  v_mfma_f32_16x16x32_bf16 a[56:59], a[200:203], v[172:175], a[56:59]
  v_and_b32 v7, 0xffff0000, v7
  v_add_f32 v104, v104, v4
  v_mfma_f32_16x16x32_bf16 a[12:15], a[204:207], v[160:163], a[12:15]
  v_add_f32 v105, v105, v5
  v_add_f32 v106, v106, v6
  v_mfma_f32_16x16x32_bf16 a[28:31], a[204:207], v[164:167], a[28:31]
  v_add_f32 v107, v107, v7
  v_lshlrev_b32 v4, 16, v70
  v_mfma_f32_16x16x32_bf16 a[44:47], a[204:207], v[168:171], a[44:47]
  v_and_b32 v5, 0xffff0000, v70
  v_lshlrev_b32 v6, 16, v71
  v_mfma_f32_16x16x32_bf16 a[60:63], a[204:207], v[172:175], a[60:63]
  v_and_b32 v7, 0xffff0000, v71
  v_lshlrev_b32 v8, 16, v78
  v_mfma_f32_16x16x32_bf16 a[0:3], a[208:211], v[176:179], a[0:3]
  v_and_b32 v9, 0xffff0000, v78
  v_lshlrev_b32 v10, 16, v79
  v_mfma_f32_16x16x32_bf16 a[16:19], a[208:211], v[180:183], a[16:19]
  v_and_b32 v11, 0xffff0000, v79
  v_lshlrev_b32 v12, 16, v86
  v_mfma_f32_16x16x32_bf16 a[32:35], a[208:211], v[184:187], a[32:35]
  v_and_b32 v13, 0xffff0000, v86
  v_lshlrev_b32 v14, 16, v87
  v_mfma_f32_16x16x32_bf16 a[48:51], a[208:211], v[188:191], a[48:51]
  v_and_b32 v15, 0xffff0000, v87
  v_add_f32 v108, v4, v12
  v_mfma_f32_16x16x32_bf16 a[4:7], a[212:215], v[176:179], a[4:7]
  v_sub_f32 v4, v4, v88
  v_add_f32 v109, v5, v13
  v_mfma_f32_16x16x32_bf16 a[20:23], a[212:215], v[180:183], a[20:23]
  v_sub_f32 v5, v5, v88
  v_add_f32 v110, v6, v14
  v_mfma_f32_16x16x32_bf16 a[36:39], a[212:215], v[184:187], a[36:39]
  v_sub_f32 v6, v6, v88
  v_add_f32 v111, v7, v15
  v_mfma_f32_16x16x32_bf16 a[52:55], a[212:215], v[188:191], a[52:55]
  v_sub_f32 v7, v7, v88
  v_cvt_pk_bf16_f32 v4, v4, v4
  v_mfma_f32_16x16x32_bf16 a[8:11], a[216:219], v[176:179], a[8:11]
  v_and_b32 v4, 0xffff0000, v4
  v_cvt_pk_bf16_f32 v5, v5, v5
  v_mfma_f32_16x16x32_bf16 a[24:27], a[216:219], v[180:183], a[24:27]
  v_and_b32 v5, 0xffff0000, v5
  v_cvt_pk_bf16_f32 v6, v6, v6
  v_mfma_f32_16x16x32_bf16 a[40:43], a[216:219], v[184:187], a[40:43]
  v_and_b32 v6, 0xffff0000, v6
  v_cvt_pk_bf16_f32 v7, v7, v7
  v_mfma_f32_16x16x32_bf16 a[56:59], a[216:219], v[188:191], a[56:59]
  v_and_b32 v7, 0xffff0000, v7
  v_mul_f32 v4, v4, v89
  v_mfma_f32_16x16x32_bf16 a[12:15], a[220:223], v[176:179], a[12:15]
  v_mul_f32 v5, v5, v89
  v_mul_f32 v6, v6, v89
  v_mfma_f32_16x16x32_bf16 a[28:31], a[220:223], v[180:183], a[28:31]
  v_mul_f32 v7, v7, v89
  v_cvt_pk_bf16_f32 v4, v4, v4
  s_waitcnt vmcnt(0)
  s_mov_b32 s51, 0
Lc20:
  v_max3_u32 v52, v192, v196, v200
  v_max3_u32 v53, v204, v208, v212
  v_max3_u32 v52, v52, v216, v220
  v_max_u32 v52, v52, v53
  v_cmp_eq_u32 vcc, -1, v52
  s_cbranch_vccz Lc20ok
  s_add_u32 s50, s96, 34560
  buffer_load_dwordx4 v[192:195], v25, s[64:67], s50 offen sc1
  buffer_load_dwordx4 v[196:199], v26, s[64:67], s50 offen sc1
  s_add_u32 s50, s97, 34560
  buffer_load_dwordx4 v[200:203], v25, s[64:67], s50 offen sc1
  buffer_load_dwordx4 v[204:207], v26, s[64:67], s50 offen sc1
  s_add_u32 s50, s96, 36608
  buffer_load_dwordx4 v[208:211], v25, s[64:67], s50 offen sc1
  buffer_load_dwordx4 v[212:215], v26, s[64:67], s50 offen sc1
  s_add_u32 s50, s97, 36608
  buffer_load_dwordx4 v[216:219], v25, s[64:67], s50 offen sc1
  buffer_load_dwordx4 v[220:223], v26, s[64:67], s50 offen sc1
  s_add_u32 s51, s51, 1
  s_waitcnt vmcnt(0)
  s_cmp_lt_u32 s51, 0x40000
  s_cbranch_scc1 Lc20
Lc20ok:
  v_mfma_f32_16x16x32_bf16 a[44:47], a[220:223], v[184:187], a[44:47]
  v_and_b32 v4, 0xffff0000, v4
  v_cvt_pk_bf16_f32 v5, v5, v5
  v_mfma_f32_16x16x32_bf16 a[60:63], a[220:223], v[188:191], a[60:63]
  v_and_b32 v5, 0xffff0000, v5
  v_cvt_pk_bf16_f32 v6, v6, v6
  v_mfma_f32_16x16x32_bf16 a[16:19], a[224:227], v[196:199], a[16:19]
  v_and_b32 v6, 0xffff0000, v6
  v_cvt_pk_bf16_f32 v7, v7, v7
  v_mfma_f32_16x16x32_bf16 a[20:23], a[228:231], v[196:199], a[20:23]
  v_and_b32 v7, 0xffff0000, v7
  v_mul_f32 v4, v4, v8
  v_mfma_f32_16x16x32_bf16 a[24:27], a[232:235], v[196:199], a[24:27]
  v_mul_f32 v5, v5, v9
  v_mul_f32 v6, v6, v10
  v_mfma_f32_16x16x32_bf16 a[28:31], a[236:239], v[196:199], a[28:31]
  v_mul_f32 v7, v7, v11
  v_cvt_pk_bf16_f32 v4, v4, v4
  v_mfma_f32_16x16x32_bf16 a[16:19], a[240:243], v[212:215], a[16:19]
  v_and_b32 v4, 0xffff0000, v4
  v_cvt_pk_bf16_f32 v5, v5, v5
  v_mfma_f32_16x16x32_bf16 a[20:23], a[244:247], v[212:215], a[20:23]
  v_and_b32 v5, 0xffff0000, v5
  v_cvt_pk_bf16_f32 v6, v6, v6
  v_mfma_f32_16x16x32_bf16 a[24:27], a[248:251], v[212:215], a[24:27]
  v_and_b32 v6, 0xffff0000, v6
  v_cvt_pk_bf16_f32 v7, v7, v7
  v_mfma_f32_16x16x32_bf16 a[28:31], a[252:255], v[212:215], a[28:31]
  v_and_b32 v7, 0xffff0000, v7
  v_add_f32 v108, v108, v4
  v_mfma_f32_16x16x32_bf16 a[32:35], a[224:227], v[200:203], a[32:35]
  v_add_f32 v109, v109, v5
  v_add_f32 v110, v110, v6
  v_mfma_f32_16x16x32_bf16 a[36:39], a[228:231], v[200:203], a[36:39]
  ds_write_b128 v44, a[16:19] offset:4096
  v_mfma_f32_16x16x32_bf16 a[40:43], a[232:235], v[200:203], a[40:43]
  v_add_f32 v111, v111, v7
  v_mfma_f32_16x16x32_bf16 a[44:47], a[236:239], v[200:203], a[44:47]
  ds_write_b128 v45, a[20:23] offset:5120
  v_mfma_f32_16x16x32_bf16 a[32:35], a[240:243], v[216:219], a[32:35]
  v_mfma_f32_16x16x32_bf16 a[36:39], a[244:247], v[216:219], a[36:39]
  ds_write_b128 v46, a[24:27] offset:6144
  v_mfma_f32_16x16x32_bf16 a[40:43], a[248:251], v[216:219], a[40:43]
  v_mfma_f32_16x16x32_bf16 a[44:47], a[252:255], v[216:219], a[44:47]
  ds_write_b128 v47, a[28:31] offset:7168
  v_mfma_f32_16x16x32_bf16 a[48:51], a[224:227], v[204:207], a[48:51]
  v_mfma_f32_16x16x32_bf16 a[52:55], a[228:231], v[204:207], a[52:55]
  s_nop 1
  ds_write_b128 v44, a[32:35] offset:8192
  v_mfma_f32_16x16x32_bf16 a[56:59], a[232:235], v[204:207], a[56:59]
  v_mfma_f32_16x16x32_bf16 a[60:63], a[236:239], v[204:207], a[60:63]
  ds_write_b128 v45, a[36:39] offset:9216
  v_mfma_f32_16x16x32_bf16 a[48:51], a[240:243], v[220:223], a[48:51]
  v_mfma_f32_16x16x32_bf16 a[52:55], a[244:247], v[220:223], a[52:55]
  ds_write_b128 v46, a[40:43] offset:10240
  v_mfma_f32_16x16x32_bf16 a[56:59], a[248:251], v[220:223], a[56:59]
  v_mfma_f32_16x16x32_bf16 a[60:63], a[252:255], v[220:223], a[60:63]
  ds_write_b128 v47, a[44:47] offset:11264
  v_mfma_f32_16x16x32_bf16 a[0:3], a[224:227], v[192:195], a[0:3]
  v_mfma_f32_16x16x32_bf16 a[4:7], a[228:231], v[192:195], a[4:7]
  s_nop 1
  ds_write_b128 v44, a[48:51] offset:12288
  v_mfma_f32_16x16x32_bf16 a[8:11], a[232:235], v[192:195], a[8:11]
  v_mfma_f32_16x16x32_bf16 a[12:15], a[236:239], v[192:195], a[12:15]
  ds_write_b128 v45, a[52:55] offset:13312
  v_mfma_f32_16x16x32_bf16 a[0:3], a[240:243], v[208:211], a[0:3]
  v_mfma_f32_16x16x32_bf16 a[4:7], a[244:247], v[208:211], a[4:7]
  ds_write_b128 v46, a[56:59] offset:14336
  v_mfma_f32_16x16x32_bf16 a[8:11], a[248:251], v[208:211], a[8:11]
  v_mfma_f32_16x16x32_bf16 a[12:15], a[252:255], v[208:211], a[12:15]
  ds_write_b128 v47, a[60:63] offset:15360
  s_nop 3
  v_accvgpr_read_b32 v4, a0
  v_accvgpr_read_b32 v5, a1
  v_accvgpr_read_b32 v6, a2
  v_accvgpr_read_b32 v7, a3
  v_add_f32 v96, v96, v4
  v_add_f32 v97, v97, v5
  v_add_f32 v98, v98, v6
  v_add_f32 v99, v99, v7
  ds_write_b128 v44, v[96:99] offset:0
  v_accvgpr_read_b32 v4, a4
  v_accvgpr_read_b32 v5, a5
  v_accvgpr_read_b32 v6, a6
  v_accvgpr_read_b32 v7, a7
  v_add_f32 v100, v100, v4
  v_add_f32 v101, v101, v5
  v_add_f32 v102, v102, v6
  v_add_f32 v103, v103, v7
  ds_write_b128 v45, v[100:103] offset:1024
  v_accvgpr_read_b32 v4, a8
  v_accvgpr_read_b32 v5, a9
  v_accvgpr_read_b32 v6, a10
  v_accvgpr_read_b32 v7, a11
  v_add_f32 v104, v104, v4
  v_add_f32 v105, v105, v5
  v_add_f32 v106, v106, v6
  v_add_f32 v107, v107, v7
  ds_write_b128 v46, v[104:107] offset:2048
  v_accvgpr_read_b32 v4, a12
  v_accvgpr_read_b32 v5, a13
  v_accvgpr_read_b32 v6, a14
  v_accvgpr_read_b32 v7, a15
  v_add_f32 v108, v108, v4
  v_add_f32 v109, v109, v5
  v_add_f32 v110, v110, v6
  v_add_f32 v111, v111, v7
  ds_write_b128 v47, v[108:111] offset:3072
  s_waitcnt lgkmcnt(0)
  s_barrier
  ds_read_b128 v[128:131], v112 offset:0
  ds_read_b128 v[144:147], v116 offset:4096
  ds_read_b128 v[160:163], v120 offset:8192
  ds_read_b128 v[176:179], v124 offset:12288
  ds_read_b128 v[132:135], v113 offset:0
  ds_read_b128 v[148:151], v117 offset:4096
  ds_read_b128 v[164:167], v121 offset:8192
  ds_read_b128 v[180:183], v125 offset:12288
  ds_read_b128 v[136:139], v114 offset:0
  ds_read_b128 v[152:155], v118 offset:4096
  ds_read_b128 v[168:171], v122 offset:8192
  ds_read_b128 v[184:187], v126 offset:12288
  ds_read_b128 v[140:143], v115 offset:0
  ds_read_b128 v[156:159], v119 offset:4096
  ds_read_b128 v[172:175], v123 offset:8192
  ds_read_b128 v[188:191], v127 offset:12288
  s_mov_b32 s15, 0
  s_waitcnt lgkmcnt(12)
  v_add_f32 v128, v128, v144
  v_add_f32 v160, v160, v176
  v_add_f32 v129, v129, v145
  v_add_f32 v161, v161, v177
  v_add_f32 v130, v130, v146
  v_add_f32 v162, v162, v178
  v_add_f32 v131, v131, v147
  v_add_f32 v163, v163, v179
  v_add_f32 v128, v128, v160
  v_add_f32 v129, v129, v161
  v_add_f32 v130, v130, v162
  v_add_f32 v131, v131, v163
  buffer_store_dwordx4 v[128:131], v40, s[80:83], s15 offen sc1 nt
  s_mov_b32 s15, 16384
  s_waitcnt lgkmcnt(8)
  v_add_f32 v132, v132, v148
  v_add_f32 v164, v164, v180
  v_add_f32 v133, v133, v149
  v_add_f32 v165, v165, v181
  v_add_f32 v134, v134, v150
  v_add_f32 v166, v166, v182
  v_add_f32 v135, v135, v151
  v_add_f32 v167, v167, v183
  v_add_f32 v132, v132, v164
  v_add_f32 v133, v133, v165
  v_add_f32 v134, v134, v166
  v_add_f32 v135, v135, v167
  buffer_store_dwordx4 v[132:135], v40, s[80:83], s15 offen sc1 nt
  s_mov_b32 s15, 32768
  s_waitcnt lgkmcnt(4)
  v_add_f32 v136, v136, v152
  v_add_f32 v168, v168, v184
  v_add_f32 v137, v137, v153
  v_add_f32 v169, v169, v185
  v_add_f32 v138, v138, v154
  v_add_f32 v170, v170, v186
  v_add_f32 v139, v139, v155
  v_add_f32 v171, v171, v187
  v_add_f32 v136, v136, v168
  v_add_f32 v137, v137, v169
  v_add_f32 v138, v138, v170
  v_add_f32 v139, v139, v171
  buffer_store_dwordx4 v[136:139], v40, s[80:83], s15 offen sc1 nt
  s_mov_b32 s15, 49152
  s_waitcnt lgkmcnt(0)
  v_add_f32 v140, v140, v156
  v_add_f32 v172, v172, v188
  v_add_f32 v141, v141, v157
  v_add_f32 v173, v173, v189
  v_add_f32 v142, v142, v158
  v_add_f32 v174, v174, v190
  v_add_f32 v143, v143, v159
  v_add_f32 v175, v175, v191
  v_add_f32 v140, v140, v172
  v_add_f32 v141, v141, v173
  v_add_f32 v142, v142, v174
  v_add_f32 v143, v143, v175
  buffer_store_dwordx4 v[140:143], v40, s[80:83], s15 offen sc1 nt
Lend:
  s_endpgm
.section .rodata,"a"
.p2align 6
.amdhsa_kernel parallel_sum__ssm_conv_s5__dense_activation_squared_relu__prompt_kernel
  .amdhsa_next_free_vgpr 512
  .amdhsa_next_free_sgpr 102
  .amdhsa_accum_offset 256
  .amdhsa_group_segment_fixed_size 0
  .amdhsa_kernarg_size 136
  .amdhsa_user_sgpr_count 2
  .amdhsa_user_sgpr_kernarg_segment_ptr 1
  .amdhsa_system_sgpr_workgroup_id_x 1
.end_amdhsa_kernel
```
